```python
import torch

def _softmax(x, axis=-1):
    return torch.softmax(x, dim=axis)

def _gelu(x):
    return torch.nn.functional.gelu(x, approximate='tanh')

def _silu(x):
    return torch.nn.functional.silu(x)

def _sigmoid(x):
    return torch.sigmoid(x)

def _layernorm(x, axis=-1, eps=1e-05):
    m = x.mean(dim=axis, keepdim=True)
    v = x.var(dim=axis, keepdim=True, unbiased=False)
    return (x - m) / torch.sqrt(v + eps)

def _scatter_add(tgt, idx, src, axis=0):
    return tgt.clone().index_add_(axis, idx, src)

def _segment_sum(src, seg, n):
    out = torch.zeros((n,) + src.shape[1:], dtype=src.dtype)
    return out.index_add_(0, seg, src)

def _pad(x, pw):
    flat = tuple((v for pair in reversed(pw) for v in pair))
    return torch.nn.functional.pad(x, flat)
kernel_name = 'standalone__autoregressive_conv_wavernn__speech'

def setup_inputs():

    _w = lambda a: (lambda t: t.to(torch.bfloat16) if t.is_floating_point() else t)(torch.as_tensor(a))
    B, T, D, K = (2, 4000, 256, 5)
    return {'x': _w((lambda *s: torch.randn(*s, dtype=torch.bfloat16) * 0.1)(B, T, D)), 'w': _w((lambda *s: torch.randn(*s, dtype=torch.bfloat16) * 0.1)(K, D, 2 * D))}

def reference(x, w):
    B, T, D = x.shape
    K = w.shape[0]
    dil = 2
    pad = (K - 1) * dil
    xp = _pad(x, ((0, 0), (pad, 0), (0, 0)))
    h = torch.einsum('btd,de->bte', xp[:, 0:T, :], w[0])
    for i in range(1, K):
        h = h + torch.einsum('btd,de->bte', xp[:, i * dil:i * dil + T, :], w[i])
    f, g = (h[..., :D].clone(), h[..., D:].clone())
    return torch.tanh(f) * _sigmoid(g)
```

```asm
; @launch grid=(256,1,1) block=(512,1,1) lds=157696
.amdgcn_target "amdgcn-amd-amdhsa--gfx950"
.text
.p2align 12
.globl standalone__autoregressive_conv_wavernn__speech_kernel
.p2align 8
.type standalone__autoregressive_conv_wavernn__speech_kernel,@function
standalone__autoregressive_conv_wavernn__speech_kernel:
s_load_dwordx2 s[4:5], s[0:1], 0
s_load_dwordx2 s[8:9], s[0:1], 8
v_readfirstlane_b32 s12, v0
s_cmpk_ge_u32 s2, 256
s_cbranch_scc1 L_end
s_cmpk_ge_u32 s12, 256
s_cbranch_scc1 L_compute
s_and_b32 s94, s2, 3
v_bfe_u32 v1, v0, 3, 4
s_and_b32 s13, s2, 0x38
v_and_b32 v2, 7, v0
s_lshl_b32 s82, s94, 16
s_mul_i32 s18, s13, 8256
v_bitop3_b32 v3, v1, 6, v2 bitop3:0x6a
s_and_b32 s18, s18, 0x60200
v_and_b32 v5, 128, v0
s_lshl3_add_u32 s18, s82, s18
s_bitcmp1_b32 s2, 2
s_cselect_b32 s17, 2048000, 0
s_add_u32 s24, s18, s17
s_and_b32 s25, s2, 0x33
v_lshl_add_u32 v4, v1, 13, s24
v_or_b32 v8, s25, v1
v_lshl_add_u32 v4, v3, 4, v4
v_cmp_ne_u32 vcc, 0, v8
v_lshl_add_u32 v4, v5, 3, v4
s_add_u32 s6, s17, 2048000
v_add_u32 v6, 0xfffff000, v4
s_lshl_b32 s23, s12, 4
v_cndmask_b32 v6, 2.0, v6, vcc
s_and_b32 s22, s12, 128
s_add_u32 s22, s22, s23
s_lshl_b32 s90, s94, 7
s_mov_b32 s7, 0x20000
v_lshrrev_b32 v10, 4, v0
v_bfe_u32 v11, v0, 3, 5
s_and_b32 s14, s2, 0xc0
v_bfi_b32 v10, 4, v10, v1
s_lshl_b32 s14, s14, 1
v_bitop3_b32 v10, v10, 6, v2 bitop3:0x6a
v_lshl_add_u32 v7, v11, 10, s14
s_mov_b32 s10, 1310720
v_lshl_add_u32 v7, v10, 4, v7
s_mov_b32 s11, 0x20000
s_add_u32 s25, s24, 126976
s_mul_i32 s19, s12, 34
v_lshl_add_u32 v9, v0, 4, s25
s_lshl_b32 s25, s13, 9
v_and_b32 v20, 9, v0
s_add_u32 s25, s25, s14
v_and_b32 v21, 0x32, v0
s_add_u32 s25, s25, s23
v_and_b32 v22, 4, v0
v_lshlrev_b32 v20, 6, v20
v_lshl_add_u32 v20, v21, 14, v20
v_lshl_add_u32 v20, v22, 18, v20
v_add_u32 v20, s25, v20
s_add_u32 m0, s22, 0
s_waitcnt lgkmcnt(0)
buffer_load_dwordx4 v6, s[4:7], s90 offen lds
s_add_u32 m0, s22, 2304
s_nop 0
buffer_load_dwordx4 v6, s[4:7], s90 offen offset:2048 lds
s_add_u32 m0, s22, 8704
s_nop 0
buffer_load_dwordx4 v4, s[4:7], s90 offen lds
s_add_u32 m0, s22, 11008
s_nop 0
buffer_load_dwordx4 v4, s[4:7], s90 offen offset:2048 lds
s_add_u32 m0, s19, 2048
s_mov_b64 exec, 0xff
buffer_load_dwordx4 v9, s[4:7], s90 offen lds
s_mov_b64 exec, -1
s_add_u32 m0, s23, 34816
s_nop 0
buffer_load_dwordx4 v7, s[8:11], s82 offen lds
s_add_u32 m0, s23, 38400
s_nop 0
buffer_load_dwordx4 v7, s[8:11], s82 offen offset:512 lds
s_mov_b32 exec_lo, 0xf0f3c3c
s_mov_b32 exec_hi, 0x3030f0f
buffer_load_dword v24, v20, s[8:11], s82 offen
s_mov_b64 exec, -1
s_add_u32 m0, s23, 43008
s_add_u32 s27, s82, 262144
buffer_load_dwordx4 v7, s[8:11], s27 offen lds
s_add_u32 m0, s23, 46592
s_nop 0
buffer_load_dwordx4 v7, s[8:11], s27 offen offset:512 lds
s_add_u32 m0, s23, 51200
s_add_u32 s27, s82, 524288
buffer_load_dwordx4 v7, s[8:11], s27 offen lds
s_branch L_loader2
L_compute:
s_bfe_u32 s12, s12, 0x20006
s_cmp_eq_u32 s12, 0
s_cbranch_scc1 L_touch0
s_cmp_eq_u32 s12, 1
s_cbranch_scc1 L_touch1
s_nop 0
s_nop 0
L_back:
v_and_b32 v0, 63, v0
s_mov_b32 s20, 0
s_mov_b32 s21, s12
v_and_b32 v21, 15, v0
v_lshrrev_b32 v22, 4, v0
s_lshl_b32 s22, s20, 4
v_add_u32 v23, s22, v21
v_add_u32 v24, 0, v23
v_and_b32 v25, 6, v24
v_xor_b32 v25, v25, v22
v_lshlrev_b32 v26, 7, v24
v_lshl_add_u32 v1, v25, 4, v26
v_xor_b32 v2, 64, v1
v_add_u32 v24, 1, v23
v_and_b32 v25, 6, v24
v_xor_b32 v25, v25, v22
v_lshlrev_b32 v26, 7, v24
v_lshl_add_u32 v3, v25, 4, v26
v_xor_b32 v4, 64, v3
v_bfe_u32 v24, v0, 2, 2
v_and_b32 v25, 3, v0
v_lshrrev_b32 v27, 1, v25
s_lshl_b32 s23, s21, 1
v_or_b32 v27, s23, v27
v_and_b32 v26, 2, v24
v_xor_b32 v27, v27, v26
v_and_b32 v26, 1, v22
v_lshlrev_b32 v26, 2, v26
v_xor_b32 v27, v27, v26
v_lshlrev_b32 v27, 4, v27
v_and_b32 v25, 1, v25
v_lshl_add_u32 v27, v25, 3, v27
v_lshl_add_u32 v24, v22, 3, v24
v_lshl_add_u32 v27, v24, 7, v27
v_add_u32 v5, 34816, v27
v_add_u32 v6, 96256, v27
v_lshrrev_b32 v24, 1, v22
v_or_b32 v24, s23, v24
v_and_b32 v25, 7, v21
v_xor_b32 v24, v24, v25
v_lshl_add_u32 v24, v21, 3, v24
v_lshlrev_b32 v24, 4, v24
v_and_b32 v25, 1, v22
v_lshl_add_u32 v24, v25, 3, v24
s_lshl_b32 s23, s20, 10
s_add_u32 s23, s23, 116736
v_add_u32 v7, s23, v24
s_mov_b32 s32, 0x4038aa3b
s_mov_b32 s33, s32
s_mov_b32 s34, 0xbfb8aa3b
s_mov_b32 s35, s34
s_mov_b32 s30, 1.0
s_mov_b32 s31, 1.0
s_mov_b32 s28, 0x41f00000
s_cmp_lg_u32 s12, s12
s_barrier
ds_read_b128 v[8:11], v1 offset:0
ds_read_b128 v[12:15], v1 offset:2176
ds_read_b128 v[16:19], v1 offset:4352
ds_read_b128 v[20:23], v1 offset:6528
ds_read_b128 v[24:27], v1 offset:8704
ds_read_b128 v[28:31], v1 offset:10880
ds_read_b128 v[32:35], v1 offset:13056
ds_read_b128 v[36:39], v1 offset:15232
s_barrier
ds_read_b64_tr_b16 v[40:41], v5 offset:0
ds_read_b64_tr_b16 v[42:43], v5 offset:512
ds_read_b64_tr_b16 v[44:45], v5 offset:4096
ds_read_b64_tr_b16 v[46:47], v5 offset:4608
s_waitcnt lgkmcnt(2)
v_mfma_f32_16x16x32_bf16 v[192:195], v[40:43], v[8:11], 0
s_waitcnt lgkmcnt(0)
v_mfma_f32_16x16x32_bf16 v[196:199], v[44:47], v[8:11], 0
v_mfma_f32_16x16x32_bf16 v[200:203], v[40:43], v[12:15], 0
v_mfma_f32_16x16x32_bf16 v[204:207], v[44:47], v[12:15], 0
v_mfma_f32_16x16x32_bf16 v[208:211], v[40:43], v[16:19], 0
v_mfma_f32_16x16x32_bf16 v[212:215], v[44:47], v[16:19], 0
v_mfma_f32_16x16x32_bf16 v[216:219], v[40:43], v[20:23], 0
ds_read_b128 v[48:51], v3 offset:0
v_mfma_f32_16x16x32_bf16 v[220:223], v[44:47], v[20:23], 0
v_mfma_f32_16x16x32_bf16 v[224:227], v[40:43], v[24:27], 0
v_mfma_f32_16x16x32_bf16 v[228:231], v[44:47], v[24:27], 0
v_mfma_f32_16x16x32_bf16 v[232:235], v[40:43], v[28:31], 0
s_barrier
v_mfma_f32_16x16x32_bf16 v[236:239], v[44:47], v[28:31], 0
ds_read_b64_tr_b16 v[52:53], v5 offset:8192
v_mfma_f32_16x16x32_bf16 v[240:243], v[40:43], v[32:35], 0
ds_read_b64_tr_b16 v[54:55], v5 offset:8704
v_mfma_f32_16x16x32_bf16 v[244:247], v[44:47], v[32:35], 0
ds_read_b64_tr_b16 v[56:57], v5 offset:12288
ds_read_b64_tr_b16 v[58:59], v5 offset:12800
v_mfma_f32_16x16x32_bf16 v[248:251], v[40:43], v[36:39], 0
v_mfma_f32_16x16x32_bf16 v[252:255], v[44:47], v[36:39], 0
s_waitcnt lgkmcnt(2)
v_mfma_f32_16x16x32_bf16 v[192:195], v[52:55], v[12:15], v[192:195]
s_waitcnt lgkmcnt(0)
v_mfma_f32_16x16x32_bf16 v[196:199], v[56:59], v[12:15], v[196:199]
v_mfma_f32_16x16x32_bf16 v[200:203], v[52:55], v[16:19], v[200:203]
v_mfma_f32_16x16x32_bf16 v[204:207], v[56:59], v[16:19], v[204:207]
v_mfma_f32_16x16x32_bf16 v[208:211], v[52:55], v[20:23], v[208:211]
v_mfma_f32_16x16x32_bf16 v[212:215], v[56:59], v[20:23], v[212:215]
v_mfma_f32_16x16x32_bf16 v[216:219], v[52:55], v[24:27], v[216:219]
ds_read_b128 v[60:63], v3 offset:2176
v_mfma_f32_16x16x32_bf16 v[220:223], v[56:59], v[24:27], v[220:223]
v_mfma_f32_16x16x32_bf16 v[224:227], v[52:55], v[28:31], v[224:227]
s_barrier
v_mfma_f32_16x16x32_bf16 v[228:231], v[56:59], v[28:31], v[228:231]
ds_read_b64_tr_b16 v[64:65], v5 offset:16384
v_mfma_f32_16x16x32_bf16 v[232:235], v[52:55], v[32:35], v[232:235]
ds_read_b64_tr_b16 v[66:67], v5 offset:16896
v_mfma_f32_16x16x32_bf16 v[236:239], v[56:59], v[32:35], v[236:239]
ds_read_b64_tr_b16 v[68:69], v5 offset:20480
ds_read_b64_tr_b16 v[70:71], v5 offset:20992
v_mfma_f32_16x16x32_bf16 v[240:243], v[52:55], v[36:39], v[240:243]
v_mfma_f32_16x16x32_bf16 v[244:247], v[56:59], v[36:39], v[244:247]
v_mfma_f32_16x16x32_bf16 v[248:251], v[52:55], v[48:51], v[248:251]
v_mfma_f32_16x16x32_bf16 v[252:255], v[56:59], v[48:51], v[252:255]
s_waitcnt lgkmcnt(2)
v_mfma_f32_16x16x32_bf16 v[192:195], v[64:67], v[16:19], v[192:195]
s_waitcnt lgkmcnt(0)
v_mfma_f32_16x16x32_bf16 v[196:199], v[68:71], v[16:19], v[196:199]
v_mfma_f32_16x16x32_bf16 v[200:203], v[64:67], v[20:23], v[200:203]
v_mfma_f32_16x16x32_bf16 v[204:207], v[68:71], v[20:23], v[204:207]
v_mfma_f32_16x16x32_bf16 v[208:211], v[64:67], v[24:27], v[208:211]
v_mfma_f32_16x16x32_bf16 v[212:215], v[68:71], v[24:27], v[212:215]
v_mfma_f32_16x16x32_bf16 v[216:219], v[64:67], v[28:31], v[216:219]
v_mfma_f32_16x16x32_bf16 v[220:223], v[68:71], v[28:31], v[220:223]
v_mfma_f32_16x16x32_bf16 v[224:227], v[64:67], v[32:35], v[224:227]
s_barrier
v_mfma_f32_16x16x32_bf16 v[228:231], v[68:71], v[32:35], v[228:231]
ds_read_b64_tr_b16 v[72:73], v5 offset:24576
v_mfma_f32_16x16x32_bf16 v[232:235], v[64:67], v[36:39], v[232:235]
ds_read_b64_tr_b16 v[74:75], v5 offset:25088
v_mfma_f32_16x16x32_bf16 v[236:239], v[68:71], v[36:39], v[236:239]
ds_read_b64_tr_b16 v[76:77], v5 offset:32768
ds_read_b64_tr_b16 v[78:79], v5 offset:33280
v_mfma_f32_16x16x32_bf16 v[240:243], v[64:67], v[48:51], v[240:243]
ds_read_b64_tr_b16 v[80:81], v5 offset:28672
ds_read_b64_tr_b16 v[82:83], v5 offset:29184
v_mfma_f32_16x16x32_bf16 v[244:247], v[68:71], v[48:51], v[244:247]
ds_read_b64_tr_b16 v[84:85], v5 offset:36864
ds_read_b64_tr_b16 v[86:87], v5 offset:37376
v_mfma_f32_16x16x32_bf16 v[248:251], v[64:67], v[60:63], v[248:251]
v_mfma_f32_16x16x32_bf16 v[252:255], v[68:71], v[60:63], v[252:255]
s_waitcnt lgkmcnt(6)
v_mfma_f32_16x16x32_bf16 v[192:195], v[72:75], v[20:23], v[192:195]
s_waitcnt lgkmcnt(4)
v_mfma_f32_16x16x32_bf16 v[192:195], v[76:79], v[24:27], v[192:195]
s_waitcnt lgkmcnt(2)
ds_read_b128 v[88:91], v3 offset:4352
v_mfma_f32_16x16x32_bf16 v[196:199], v[80:83], v[20:23], v[196:199]
s_waitcnt lgkmcnt(1)
v_mfma_f32_16x16x32_bf16 v[196:199], v[84:87], v[24:27], v[196:199]
v_mfma_f32_16x16x32_bf16 v[200:203], v[72:75], v[24:27], v[200:203]
v_mfma_f32_16x16x32_bf16 v[200:203], v[76:79], v[28:31], v[200:203]
ds_read_b128 v[92:95], v3 offset:6528
v_mfma_f32_16x16x32_bf16 v[204:207], v[80:83], v[24:27], v[204:207]
v_mfma_f32_16x16x32_bf16 v[204:207], v[84:87], v[28:31], v[204:207]
v_mfma_f32_16x16x32_bf16 v[208:211], v[72:75], v[28:31], v[208:211]
ds_read_b128 v[96:99], v2 offset:0
v_mfma_f32_16x16x32_bf16 v[208:211], v[76:79], v[32:35], v[208:211]
ds_read_b128 v[100:103], v2 offset:2176
v_mfma_f32_16x16x32_bf16 v[212:215], v[80:83], v[28:31], v[212:215]
ds_read_b128 v[104:107], v2 offset:4352
v_mfma_f32_16x16x32_bf16 v[212:215], v[84:87], v[32:35], v[212:215]
v_mfma_f32_16x16x32_bf16 v[216:219], v[72:75], v[32:35], v[216:219]
v_mfma_f32_16x16x32_bf16 v[216:219], v[76:79], v[36:39], v[216:219]
v_mfma_f32_16x16x32_bf16 v[220:223], v[80:83], v[32:35], v[220:223]
s_barrier
v_mfma_f32_16x16x32_bf16 v[220:223], v[84:87], v[36:39], v[220:223]
ds_read_b64_tr_b16 v[108:109], v5 offset:40960
v_mfma_f32_16x16x32_bf16 v[224:227], v[72:75], v[36:39], v[224:227]
ds_read_b64_tr_b16 v[110:111], v5 offset:41472
v_mfma_f32_16x16x32_bf16 v[224:227], v[76:79], v[48:51], v[224:227]
ds_read_b64_tr_b16 v[112:113], v5 offset:49152
v_mfma_f32_16x16x32_bf16 v[228:231], v[80:83], v[36:39], v[228:231]
ds_read_b64_tr_b16 v[114:115], v5 offset:49664
ds_read_b128 v[116:119], v2 offset:6528
v_mfma_f32_16x16x32_bf16 v[228:231], v[84:87], v[48:51], v[228:231]
ds_read_b64_tr_b16 v[120:121], v5 offset:57344
ds_read_b64_tr_b16 v[122:123], v5 offset:57856
v_mfma_f32_16x16x32_bf16 v[232:235], v[72:75], v[48:51], v[232:235]
ds_read_b64_tr_b16 v[124:125], v5 offset:45056
ds_read_b64_tr_b16 v[126:127], v5 offset:45568
v_mfma_f32_16x16x32_bf16 v[232:235], v[76:79], v[60:63], v[232:235]
ds_read_b64_tr_b16 v[128:129], v5 offset:53248
ds_read_b64_tr_b16 v[130:131], v5 offset:53760
v_mfma_f32_16x16x32_bf16 v[236:239], v[80:83], v[48:51], v[236:239]
ds_read_b64_tr_b16 v[132:133], v6 offset:0
ds_read_b64_tr_b16 v[134:135], v6 offset:512
v_mfma_f32_16x16x32_bf16 v[236:239], v[84:87], v[60:63], v[236:239]
ds_read_b128 v[136:139], v2 offset:8704
v_mfma_f32_16x16x32_bf16 v[240:243], v[72:75], v[60:63], v[240:243]
s_waitcnt lgkmcnt(15)
v_mfma_f32_16x16x32_bf16 v[240:243], v[76:79], v[88:91], v[240:243]
v_mfma_f32_16x16x32_bf16 v[244:247], v[80:83], v[60:63], v[244:247]
v_mfma_f32_16x16x32_bf16 v[244:247], v[84:87], v[88:91], v[244:247]
v_mfma_f32_16x16x32_bf16 v[248:251], v[72:75], v[88:91], v[248:251]
ds_read_b128 v[140:143], v2 offset:10880
v_mfma_f32_16x16x32_bf16 v[248:251], v[76:79], v[92:95], v[248:251]
v_mfma_f32_16x16x32_bf16 v[252:255], v[80:83], v[88:91], v[252:255]
v_mfma_f32_16x16x32_bf16 v[252:255], v[84:87], v[92:95], v[252:255]
s_waitcnt lgkmcnt(13)
v_mfma_f32_16x16x32_bf16 v[192:195], v[108:111], v[96:99], v[192:195]
s_waitcnt lgkmcnt(11)
v_mfma_f32_16x16x32_bf16 v[192:195], v[112:115], v[100:103], v[192:195]
s_waitcnt lgkmcnt(8)
v_mfma_f32_16x16x32_bf16 v[192:195], v[120:123], v[104:107], v[192:195]
s_waitcnt lgkmcnt(6)
ds_read_b128 v[144:147], v2 offset:13056
v_mfma_f32_16x16x32_bf16 v[196:199], v[124:127], v[96:99], v[196:199]
s_waitcnt lgkmcnt(5)
v_mfma_f32_16x16x32_bf16 v[196:199], v[128:131], v[100:103], v[196:199]
s_waitcnt lgkmcnt(3)
v_mfma_f32_16x16x32_bf16 v[196:199], v[132:135], v[104:107], v[196:199]
v_mfma_f32_16x16x32_bf16 v[200:203], v[108:111], v[100:103], v[200:203]
v_mfma_f32_16x16x32_bf16 v[200:203], v[112:115], v[104:107], v[200:203]
v_mfma_f32_16x16x32_bf16 v[200:203], v[120:123], v[116:119], v[200:203]
ds_read_b128 v[148:151], v2 offset:15232
v_mfma_f32_16x16x32_bf16 v[204:207], v[124:127], v[100:103], v[204:207]
v_mfma_f32_16x16x32_bf16 v[204:207], v[128:131], v[104:107], v[204:207]
v_mfma_f32_16x16x32_bf16 v[204:207], v[132:135], v[116:119], v[204:207]
v_mfma_f32_16x16x32_bf16 v[208:211], v[108:111], v[104:107], v[208:211]
v_mfma_f32_16x16x32_bf16 v[208:211], v[112:115], v[116:119], v[208:211]
s_waitcnt lgkmcnt(3)
v_mfma_f32_16x16x32_bf16 v[208:211], v[120:123], v[136:139], v[208:211]
ds_read_b128 v[152:155], v4 offset:0
v_mfma_f32_16x16x32_bf16 v[212:215], v[124:127], v[104:107], v[212:215]
v_mfma_f32_16x16x32_bf16 v[212:215], v[128:131], v[116:119], v[212:215]
v_mfma_f32_16x16x32_bf16 v[212:215], v[132:135], v[136:139], v[212:215]
v_mfma_f32_16x16x32_bf16 v[216:219], v[108:111], v[116:119], v[216:219]
v_mfma_f32_16x16x32_bf16 v[216:219], v[112:115], v[136:139], v[216:219]
s_waitcnt lgkmcnt(3)
v_mfma_f32_16x16x32_bf16 v[216:219], v[120:123], v[140:143], v[216:219]
ds_read_b128 v[156:159], v4 offset:2176
v_mfma_f32_16x16x32_bf16 v[220:223], v[124:127], v[116:119], v[220:223]
v_mfma_f32_16x16x32_bf16 v[220:223], v[128:131], v[136:139], v[220:223]
v_mfma_f32_16x16x32_bf16 v[220:223], v[132:135], v[140:143], v[220:223]
v_mfma_f32_16x16x32_bf16 v[224:227], v[108:111], v[136:139], v[224:227]
v_mfma_f32_16x16x32_bf16 v[224:227], v[112:115], v[140:143], v[224:227]
s_waitcnt lgkmcnt(3)
v_mfma_f32_16x16x32_bf16 v[224:227], v[120:123], v[144:147], v[224:227]
v_mfma_f32_16x16x32_bf16 v[228:231], v[124:127], v[136:139], v[228:231]
v_mfma_f32_16x16x32_bf16 v[228:231], v[128:131], v[140:143], v[228:231]
v_mfma_f32_16x16x32_bf16 v[228:231], v[132:135], v[144:147], v[228:231]
v_mfma_f32_16x16x32_bf16 v[232:235], v[108:111], v[140:143], v[232:235]
v_mfma_f32_16x16x32_bf16 v[232:235], v[112:115], v[144:147], v[232:235]
s_waitcnt lgkmcnt(2)
v_mfma_f32_16x16x32_bf16 v[232:235], v[120:123], v[148:151], v[232:235]
s_barrier
v_mfma_f32_16x16x32_bf16 v[236:239], v[124:127], v[140:143], v[236:239]
ds_read_b64_tr_b16 v[160:161], v6 offset:4096
v_mfma_f32_16x16x32_bf16 v[236:239], v[128:131], v[144:147], v[236:239]
ds_read_b64_tr_b16 v[162:163], v6 offset:4608
v_mfma_f32_16x16x32_bf16 v[236:239], v[132:135], v[148:151], v[236:239]
ds_read_b64_tr_b16 v[164:165], v6 offset:12288
v_mfma_f32_16x16x32_bf16 v[240:243], v[108:111], v[144:147], v[240:243]
ds_read_b64_tr_b16 v[166:167], v6 offset:12800
v_mfma_f32_16x16x32_bf16 v[240:243], v[112:115], v[148:151], v[240:243]
s_waitcnt lgkmcnt(5)
ds_read_b64_tr_b16 v[168:169], v6 offset:8192
ds_read_b64_tr_b16 v[170:171], v6 offset:8704
v_mfma_f32_16x16x32_bf16 v[240:243], v[120:123], v[152:155], v[240:243]
ds_read_b64_tr_b16 v[172:173], v6 offset:16384
ds_read_b64_tr_b16 v[174:175], v6 offset:16896
v_mfma_f32_16x16x32_bf16 v[244:247], v[124:127], v[144:147], v[244:247]
v_mfma_f32_16x16x32_bf16 v[244:247], v[128:131], v[148:151], v[244:247]
v_mfma_f32_16x16x32_bf16 v[244:247], v[132:135], v[152:155], v[244:247]
v_mfma_f32_16x16x32_bf16 v[248:251], v[108:111], v[148:151], v[248:251]
v_mfma_f32_16x16x32_bf16 v[248:251], v[112:115], v[152:155], v[248:251]
s_waitcnt lgkmcnt(8)
v_mfma_f32_16x16x32_bf16 v[248:251], v[120:123], v[156:159], v[248:251]
v_mfma_f32_16x16x32_bf16 v[252:255], v[124:127], v[148:151], v[252:255]
v_mfma_f32_16x16x32_bf16 v[252:255], v[128:131], v[152:155], v[252:255]
v_mfma_f32_16x16x32_bf16 v[252:255], v[132:135], v[156:159], v[252:255]
s_waitcnt lgkmcnt(6)
v_mfma_f32_16x16x32_bf16 v[192:195], v[160:163], v[116:119], v[192:195]
s_waitcnt lgkmcnt(4)
v_mfma_f32_16x16x32_bf16 v[192:195], v[164:167], v[136:139], v[192:195]
s_waitcnt lgkmcnt(2)
ds_read_b128 v[176:179], v4 offset:4352
v_mfma_f32_16x16x32_bf16 v[196:199], v[168:171], v[116:119], v[196:199]
s_waitcnt lgkmcnt(1)
v_mfma_f32_16x16x32_bf16 v[196:199], v[172:175], v[136:139], v[196:199]
v_mfma_f32_16x16x32_bf16 v[200:203], v[160:163], v[136:139], v[200:203]
v_mfma_f32_16x16x32_bf16 v[200:203], v[164:167], v[140:143], v[200:203]
ds_read_b128 v[180:183], v4 offset:6528
v_mfma_f32_16x16x32_bf16 v[204:207], v[168:171], v[136:139], v[204:207]
v_mfma_f32_16x16x32_bf16 v[204:207], v[172:175], v[140:143], v[204:207]
v_mfma_f32_16x16x32_bf16 v[208:211], v[160:163], v[140:143], v[208:211]
v_mfma_f32_16x16x32_bf16 v[208:211], v[164:167], v[144:147], v[208:211]
v_mfma_f32_16x16x32_bf16 v[212:215], v[168:171], v[140:143], v[212:215]
v_mfma_f32_16x16x32_bf16 v[212:215], v[172:175], v[144:147], v[212:215]
v_mfma_f32_16x16x32_bf16 v[216:219], v[160:163], v[144:147], v[216:219]
s_barrier
v_mfma_f32_16x16x32_bf16 v[216:219], v[164:167], v[148:151], v[216:219]
ds_read_b64_tr_b16 v[184:185], v6 offset:20480
v_mfma_f32_16x16x32_bf16 v[220:223], v[168:171], v[144:147], v[220:223]
ds_read_b64_tr_b16 v[186:187], v6 offset:20992
v_mfma_f32_16x16x32_bf16 v[220:223], v[172:175], v[148:151], v[220:223]
ds_read_b128 v[188:191], v1 offset:17408
ds_read_b128 v[8:11], v1 offset:19584
v_mfma_f32_16x16x32_bf16 v[224:227], v[160:163], v[148:151], v[224:227]
ds_read_b128 v[40:43], v1 offset:21760
v_mfma_f32_16x16x32_bf16 v[224:227], v[164:167], v[152:155], v[224:227]
ds_read_b64_tr_b16 v[44:45], v6 offset:28672
ds_read_b64_tr_b16 v[46:47], v6 offset:29184
v_mfma_f32_16x16x32_bf16 v[228:231], v[168:171], v[148:151], v[228:231]
ds_read_b64_tr_b16 v[12:13], v6 offset:24576
v_mfma_f32_16x16x32_bf16 v[228:231], v[172:175], v[152:155], v[228:231]
ds_read_b64_tr_b16 v[14:15], v6 offset:25088
ds_read_b128 v[52:55], v1 offset:23936
v_mfma_f32_16x16x32_bf16 v[232:235], v[160:163], v[152:155], v[232:235]
ds_read_b64_tr_b16 v[56:57], v6 offset:32768
v_mfma_f32_16x16x32_bf16 v[232:235], v[164:167], v[156:159], v[232:235]
ds_read_b64_tr_b16 v[58:59], v6 offset:33280
v_mfma_f32_16x16x32_bf16 v[236:239], v[168:171], v[152:155], v[236:239]
ds_read_b128 v[16:19], v1 offset:26112
v_mfma_f32_16x16x32_bf16 v[236:239], v[172:175], v[156:159], v[236:239]
v_mfma_f32_16x16x32_bf16 v[240:243], v[160:163], v[156:159], v[240:243]
s_waitcnt lgkmcnt(14)
v_mfma_f32_16x16x32_bf16 v[240:243], v[164:167], v[176:179], v[240:243]
ds_read_b128 v[64:67], v1 offset:28288
v_mfma_f32_16x16x32_bf16 v[244:247], v[168:171], v[156:159], v[244:247]
v_mfma_f32_16x16x32_bf16 v[244:247], v[172:175], v[176:179], v[244:247]
v_mfma_f32_16x16x32_bf16 v[248:251], v[160:163], v[176:179], v[248:251]
s_waitcnt lgkmcnt(14)
v_mfma_f32_16x16x32_bf16 v[248:251], v[164:167], v[180:183], v[248:251]
ds_read_b128 v[68:71], v1 offset:30464
v_mfma_f32_16x16x32_bf16 v[252:255], v[168:171], v[176:179], v[252:255]
v_mfma_f32_16x16x32_bf16 v[252:255], v[172:175], v[180:183], v[252:255]
s_waitcnt lgkmcnt(12)
v_mfma_f32_16x16x32_bf16 v[192:195], v[184:187], v[188:191], v[192:195]
s_waitcnt lgkmcnt(8)
v_mfma_f32_16x16x32_bf16 v[192:195], v[44:47], v[8:11], v[192:195]
s_waitcnt lgkmcnt(6)
ds_read_b128 v[20:23], v1 offset:32640
v_mfma_f32_16x16x32_bf16 v[196:199], v[12:15], v[188:191], v[196:199]
s_waitcnt lgkmcnt(4)
v_mfma_f32_16x16x32_bf16 v[196:199], v[56:59], v[8:11], v[196:199]
v_mfma_f32_16x16x32_bf16 v[200:203], v[184:187], v[8:11], v[200:203]
v_mfma_f32_16x16x32_bf16 v[200:203], v[44:47], v[40:43], v[200:203]
ds_read_b128 v[24:27], v3 offset:17408
v_mfma_f32_16x16x32_bf16 v[204:207], v[12:15], v[8:11], v[204:207]
v_mfma_f32_16x16x32_bf16 v[204:207], v[56:59], v[40:43], v[204:207]
v_mfma_f32_16x16x32_bf16 v[208:211], v[184:187], v[40:43], v[208:211]
v_mfma_f32_16x16x32_bf16 v[208:211], v[44:47], v[52:55], v[208:211]
v_mfma_f32_16x16x32_bf16 v[212:215], v[12:15], v[40:43], v[212:215]
v_mfma_f32_16x16x32_bf16 v[212:215], v[56:59], v[52:55], v[212:215]
v_mfma_f32_16x16x32_bf16 v[216:219], v[184:187], v[52:55], v[216:219]
s_waitcnt lgkmcnt(4)
v_mfma_f32_16x16x32_bf16 v[216:219], v[44:47], v[16:19], v[216:219]
v_mfma_f32_16x16x32_bf16 v[220:223], v[12:15], v[52:55], v[220:223]
s_barrier
v_mfma_f32_16x16x32_bf16 v[220:223], v[56:59], v[16:19], v[220:223]
ds_read_b64_tr_b16 v[28:29], v6 offset:36864
v_mfma_f32_16x16x32_bf16 v[224:227], v[184:187], v[16:19], v[224:227]
s_waitcnt lgkmcnt(4)
ds_read_b64_tr_b16 v[30:31], v6 offset:37376
v_mfma_f32_16x16x32_bf16 v[224:227], v[44:47], v[64:67], v[224:227]
ds_read_b64_tr_b16 v[32:33], v6 offset:45056
v_mfma_f32_16x16x32_bf16 v[228:231], v[12:15], v[16:19], v[228:231]
ds_read_b64_tr_b16 v[34:35], v6 offset:45568
v_mfma_f32_16x16x32_bf16 v[228:231], v[56:59], v[64:67], v[228:231]
ds_read_b64_tr_b16 v[36:37], v6 offset:53248
ds_read_b64_tr_b16 v[38:39], v6 offset:53760
v_mfma_f32_16x16x32_bf16 v[232:235], v[184:187], v[64:67], v[232:235]
s_waitcnt lgkmcnt(8)
ds_read_b64_tr_b16 v[48:49], v6 offset:40960
ds_read_b64_tr_b16 v[50:51], v6 offset:41472
v_mfma_f32_16x16x32_bf16 v[232:235], v[44:47], v[68:71], v[232:235]
ds_read_b64_tr_b16 v[60:61], v6 offset:49152
ds_read_b64_tr_b16 v[62:63], v6 offset:49664
v_mfma_f32_16x16x32_bf16 v[236:239], v[12:15], v[64:67], v[236:239]
ds_read_b64_tr_b16 v[72:73], v6 offset:57344
ds_read_b64_tr_b16 v[74:75], v6 offset:57856
v_mfma_f32_16x16x32_bf16 v[236:239], v[56:59], v[68:71], v[236:239]
v_mfma_f32_16x16x32_bf16 v[240:243], v[184:187], v[68:71], v[240:243]
s_waitcnt lgkmcnt(13)
v_mfma_f32_16x16x32_bf16 v[240:243], v[44:47], v[20:23], v[240:243]
v_mfma_f32_16x16x32_bf16 v[244:247], v[12:15], v[68:71], v[244:247]
v_mfma_f32_16x16x32_bf16 v[244:247], v[56:59], v[20:23], v[244:247]
v_mfma_f32_16x16x32_bf16 v[248:251], v[184:187], v[20:23], v[248:251]
L_touch0:
s_cbranch_scc1 L_back
s_waitcnt lgkmcnt(12)
v_mfma_f32_16x16x32_bf16 v[248:251], v[44:47], v[24:27], v[248:251]
v_mfma_f32_16x16x32_bf16 v[252:255], v[12:15], v[20:23], v[252:255]
v_mfma_f32_16x16x32_bf16 v[252:255], v[56:59], v[24:27], v[252:255]
s_waitcnt lgkmcnt(10)
v_mfma_f32_16x16x32_bf16 v[192:195], v[28:31], v[40:43], v[192:195]
s_waitcnt lgkmcnt(8)
v_mfma_f32_16x16x32_bf16 v[192:195], v[32:35], v[52:55], v[192:195]
s_waitcnt lgkmcnt(6)
v_mfma_f32_16x16x32_bf16 v[192:195], v[36:39], v[16:19], v[192:195]
s_waitcnt lgkmcnt(4)
v_mfma_f32_16x16x32_bf16 v[196:199], v[48:51], v[40:43], v[196:199]
s_waitcnt lgkmcnt(2)
v_mfma_f32_16x16x32_bf16 v[196:199], v[60:63], v[52:55], v[196:199]
s_waitcnt lgkmcnt(0)
v_mfma_f32_16x16x32_bf16 v[196:199], v[72:75], v[16:19], v[196:199]
v_mfma_f32_16x16x32_bf16 v[200:203], v[28:31], v[52:55], v[200:203]
v_mfma_f32_16x16x32_bf16 v[200:203], v[32:35], v[16:19], v[200:203]
v_mfma_f32_16x16x32_bf16 v[200:203], v[36:39], v[64:67], v[200:203]
ds_read_b128 v[76:79], v3 offset:19584
v_mfma_f32_16x16x32_bf16 v[204:207], v[48:51], v[52:55], v[204:207]
v_mfma_f32_16x16x32_bf16 v[204:207], v[60:63], v[16:19], v[204:207]
v_mfma_f32_16x16x32_bf16 v[204:207], v[72:75], v[64:67], v[204:207]
v_mfma_f32_16x16x32_bf16 v[208:211], v[28:31], v[16:19], v[208:211]
v_mfma_f32_16x16x32_bf16 v[208:211], v[32:35], v[64:67], v[208:211]
v_mfma_f32_16x16x32_bf16 v[208:211], v[36:39], v[68:71], v[208:211]
ds_read_b128 v[80:83], v3 offset:21760
v_mfma_f32_16x16x32_bf16 v[212:215], v[48:51], v[16:19], v[212:215]
v_mfma_f32_16x16x32_bf16 v[212:215], v[60:63], v[64:67], v[212:215]
v_mfma_f32_16x16x32_bf16 v[212:215], v[72:75], v[68:71], v[212:215]
v_mfma_f32_16x16x32_bf16 v[216:219], v[28:31], v[64:67], v[216:219]
v_mfma_f32_16x16x32_bf16 v[216:219], v[32:35], v[68:71], v[216:219]
v_mfma_f32_16x16x32_bf16 v[216:219], v[36:39], v[20:23], v[216:219]
ds_read_b128 v[88:91], v3 offset:23936
v_mfma_f32_16x16x32_bf16 v[220:223], v[48:51], v[64:67], v[220:223]
v_mfma_f32_16x16x32_bf16 v[220:223], v[60:63], v[68:71], v[220:223]
v_mfma_f32_16x16x32_bf16 v[220:223], v[72:75], v[20:23], v[220:223]
s_barrier
v_mfma_f32_16x16x32_bf16 v[224:227], v[28:31], v[68:71], v[224:227]
ds_read_b64_tr_b16 v[84:85], v5 offset:0
v_mfma_f32_16x16x32_bf16 v[224:227], v[32:35], v[20:23], v[224:227]
ds_read_b64_tr_b16 v[86:87], v5 offset:512
v_mfma_f32_16x16x32_bf16 v[224:227], v[36:39], v[24:27], v[224:227]
ds_read_b128 v[92:95], v2 offset:17408
v_mfma_f32_16x16x32_bf16 v[228:231], v[48:51], v[68:71], v[228:231]
ds_read_b64_tr_b16 v[96:97], v5 offset:8192
ds_read_b64_tr_b16 v[98:99], v5 offset:8704
v_mfma_f32_16x16x32_bf16 v[228:231], v[60:63], v[20:23], v[228:231]
ds_read_b128 v[100:103], v2 offset:19584
ds_read_b64_tr_b16 v[104:105], v5 offset:16384
v_mfma_f32_16x16x32_bf16 v[228:231], v[72:75], v[24:27], v[228:231]
ds_read_b64_tr_b16 v[106:107], v5 offset:16896
ds_read_b128 v[108:111], v2 offset:21760
v_mfma_f32_16x16x32_bf16 v[232:235], v[28:31], v[20:23], v[232:235]
ds_read_b128 v[112:115], v2 offset:23936
ds_read_b64_tr_b16 v[120:121], v5 offset:24576
v_mfma_f32_16x16x32_bf16 v[232:235], v[32:35], v[24:27], v[232:235]
s_waitcnt lgkmcnt(13)
ds_read_b64_tr_b16 v[122:123], v5 offset:25088
ds_read_b128 v[124:127], v2 offset:26112
v_mfma_f32_16x16x32_bf16 v[232:235], v[36:39], v[76:79], v[232:235]
ds_read_b64_tr_b16 v[128:129], v5 offset:32768
ds_read_b64_tr_b16 v[130:131], v5 offset:33280
v_mfma_f32_16x16x32_bf16 v[236:239], v[48:51], v[20:23], v[236:239]
ds_read_b64_tr_b16 v[132:133], v5 offset:4096
ds_read_b64_tr_b16 v[134:135], v5 offset:4608
v_mfma_f32_16x16x32_bf16 v[236:239], v[60:63], v[24:27], v[236:239]
ds_read_b64_tr_b16 v[116:117], v5 offset:12288
ds_read_b64_tr_b16 v[118:119], v5 offset:12800
v_mfma_f32_16x16x32_bf16 v[236:239], v[72:75], v[76:79], v[236:239]
ds_read_b64_tr_b16 v[136:137], v5 offset:20480
ds_read_b64_tr_b16 v[138:139], v5 offset:20992
v_mfma_f32_16x16x32_bf16 v[240:243], v[28:31], v[24:27], v[240:243]
ds_read_b64_tr_b16 v[140:141], v5 offset:28672
v_mfma_f32_16x16x32_bf16 v[240:243], v[32:35], v[76:79], v[240:243]
s_waitcnt lgkmcnt(15)
ds_read_b64_tr_b16 v[142:143], v5 offset:29184
v_mfma_f32_16x16x32_bf16 v[240:243], v[36:39], v[80:83], v[240:243]
ds_read_b64_tr_b16 v[144:145], v5 offset:36864
ds_read_b64_tr_b16 v[146:147], v5 offset:37376
v_mfma_f32_16x16x32_bf16 v[244:247], v[48:51], v[24:27], v[244:247]
ds_read_b128 v[148:151], v2 offset:28288
v_mfma_f32_16x16x32_bf16 v[244:247], v[60:63], v[76:79], v[244:247]
v_mfma_f32_16x16x32_bf16 v[244:247], v[72:75], v[80:83], v[244:247]
v_mfma_f32_16x16x32_bf16 v[248:251], v[28:31], v[76:79], v[248:251]
v_mfma_f32_16x16x32_bf16 v[248:251], v[32:35], v[80:83], v[248:251]
v_mfma_f32_16x16x32_bf16 v[248:251], v[36:39], v[88:91], v[248:251]
v_mfma_f32_16x16x32_bf16 v[252:255], v[48:51], v[76:79], v[252:255]
v_mfma_f32_16x16x32_bf16 v[252:255], v[60:63], v[80:83], v[252:255]
v_mfma_f32_16x16x32_bf16 v[252:255], v[72:75], v[88:91], v[252:255]
v_mfma_f32_16x16x32_bf16 v[192:195], v[84:87], v[92:95], v[192:195]
ds_read_b128 v[152:155], v2 offset:30464
v_mfma_f32_16x16x32_bf16 v[192:195], v[96:99], v[100:103], v[192:195]
s_waitcnt lgkmcnt(15)
v_mfma_f32_16x16x32_bf16 v[192:195], v[104:107], v[108:111], v[192:195]
v_mfma_f32_16x16x32_bf16 v[192:195], v[120:123], v[112:115], v[192:195]
s_waitcnt lgkmcnt(12)
v_mfma_f32_16x16x32_bf16 v[192:195], v[128:131], v[124:127], v[192:195]
s_waitcnt lgkmcnt(10)
v_mfma_f32_16x16x32_bf16 v[196:199], v[132:135], v[92:95], v[196:199]
s_waitcnt lgkmcnt(8)
v_mfma_f32_16x16x32_bf16 v[196:199], v[116:119], v[100:103], v[196:199]
s_waitcnt lgkmcnt(6)
v_mfma_f32_16x16x32_bf16 v[196:199], v[136:139], v[108:111], v[196:199]
s_waitcnt lgkmcnt(4)
v_mfma_f32_16x16x32_bf16 v[196:199], v[140:143], v[112:115], v[196:199]
s_waitcnt lgkmcnt(2)
v_mfma_f32_16x16x32_bf16 v[196:199], v[144:147], v[124:127], v[196:199]
v_mfma_f32_16x16x32_bf16 v[200:203], v[84:87], v[100:103], v[200:203]
ds_read_b128 v[156:159], v2 offset:32640
v_mfma_f32_16x16x32_bf16 v[200:203], v[96:99], v[108:111], v[200:203]
v_mfma_f32_16x16x32_bf16 v[200:203], v[104:107], v[112:115], v[200:203]
v_mfma_f32_16x16x32_bf16 v[200:203], v[120:123], v[124:127], v[200:203]
s_waitcnt lgkmcnt(2)
v_mfma_f32_16x16x32_bf16 v[200:203], v[128:131], v[148:151], v[200:203]
v_mfma_f32_16x16x32_bf16 v[204:207], v[132:135], v[100:103], v[204:207]
v_mfma_f32_16x16x32_bf16 v[204:207], v[116:119], v[108:111], v[204:207]
v_mfma_f32_16x16x32_bf16 v[204:207], v[136:139], v[112:115], v[204:207]
v_mfma_f32_16x16x32_bf16 v[204:207], v[140:143], v[124:127], v[204:207]
v_mfma_f32_16x16x32_bf16 v[204:207], v[144:147], v[148:151], v[204:207]
v_mfma_f32_16x16x32_bf16 v[208:211], v[84:87], v[108:111], v[208:211]
ds_read_b128 v[160:163], v4 offset:17408
v_mfma_f32_16x16x32_bf16 v[208:211], v[96:99], v[112:115], v[208:211]
v_mfma_f32_16x16x32_bf16 v[208:211], v[104:107], v[124:127], v[208:211]
v_mfma_f32_16x16x32_bf16 v[208:211], v[120:123], v[148:151], v[208:211]
s_waitcnt lgkmcnt(2)
v_mfma_f32_16x16x32_bf16 v[208:211], v[128:131], v[152:155], v[208:211]
v_mfma_f32_16x16x32_bf16 v[212:215], v[132:135], v[108:111], v[212:215]
v_mfma_f32_16x16x32_bf16 v[212:215], v[116:119], v[112:115], v[212:215]
v_mfma_f32_16x16x32_bf16 v[212:215], v[136:139], v[124:127], v[212:215]
v_mfma_f32_16x16x32_bf16 v[212:215], v[140:143], v[148:151], v[212:215]
v_mfma_f32_16x16x32_bf16 v[212:215], v[144:147], v[152:155], v[212:215]
v_mfma_f32_16x16x32_bf16 v[216:219], v[84:87], v[112:115], v[216:219]
ds_read_b128 v[164:167], v4 offset:19584
v_mfma_f32_16x16x32_bf16 v[216:219], v[96:99], v[124:127], v[216:219]
v_mfma_f32_16x16x32_bf16 v[216:219], v[104:107], v[148:151], v[216:219]
v_mfma_f32_16x16x32_bf16 v[216:219], v[120:123], v[152:155], v[216:219]
s_waitcnt lgkmcnt(2)
v_mfma_f32_16x16x32_bf16 v[216:219], v[128:131], v[156:159], v[216:219]
v_mfma_f32_16x16x32_bf16 v[220:223], v[132:135], v[112:115], v[220:223]
v_mfma_f32_16x16x32_bf16 v[220:223], v[116:119], v[124:127], v[220:223]
v_mfma_f32_16x16x32_bf16 v[220:223], v[136:139], v[148:151], v[220:223]
v_mfma_f32_16x16x32_bf16 v[220:223], v[140:143], v[152:155], v[220:223]
v_mfma_f32_16x16x32_bf16 v[220:223], v[144:147], v[156:159], v[220:223]
v_mfma_f32_16x16x32_bf16 v[224:227], v[84:87], v[124:127], v[224:227]
ds_read_b128 v[168:171], v4 offset:21760
v_mfma_f32_16x16x32_bf16 v[224:227], v[96:99], v[148:151], v[224:227]
v_mfma_f32_16x16x32_bf16 v[224:227], v[104:107], v[152:155], v[224:227]
v_mfma_f32_16x16x32_bf16 v[224:227], v[120:123], v[156:159], v[224:227]
s_waitcnt lgkmcnt(2)
v_mfma_f32_16x16x32_bf16 v[224:227], v[128:131], v[160:163], v[224:227]
v_mfma_f32_16x16x32_bf16 v[228:231], v[132:135], v[124:127], v[228:231]
v_mfma_f32_16x16x32_bf16 v[228:231], v[116:119], v[148:151], v[228:231]
v_mfma_f32_16x16x32_bf16 v[228:231], v[136:139], v[152:155], v[228:231]
v_mfma_f32_16x16x32_bf16 v[228:231], v[140:143], v[156:159], v[228:231]
v_mfma_f32_16x16x32_bf16 v[228:231], v[144:147], v[160:163], v[228:231]
v_mfma_f32_16x16x32_bf16 v[232:235], v[84:87], v[148:151], v[232:235]
s_barrier
v_mfma_f32_16x16x32_bf16 v[232:235], v[96:99], v[152:155], v[232:235]
ds_read_b128 v[176:179], v4 offset:23936
v_mfma_f32_16x16x32_bf16 v[232:235], v[104:107], v[156:159], v[232:235]
ds_read_b64_tr_b16 v[172:173], v5 offset:40960
v_mfma_f32_16x16x32_bf16 v[232:235], v[120:123], v[160:163], v[232:235]
s_waitcnt lgkmcnt(3)
ds_read_b64_tr_b16 v[174:175], v5 offset:41472
v_mfma_f32_16x16x32_bf16 v[232:235], v[128:131], v[164:167], v[232:235]
ds_read_b64_tr_b16 v[180:181], v5 offset:49152
ds_read_b64_tr_b16 v[182:183], v5 offset:49664
v_mfma_f32_16x16x32_bf16 v[236:239], v[132:135], v[148:151], v[236:239]
ds_read_b64_tr_b16 v[188:189], v5 offset:57344
v_mfma_f32_16x16x32_bf16 v[236:239], v[116:119], v[152:155], v[236:239]
ds_read_b64_tr_b16 v[190:191], v5 offset:57856
v_mfma_f32_16x16x32_bf16 v[236:239], v[136:139], v[156:159], v[236:239]
ds_read_b128 v[8:11], v1 offset:0
v_mfma_f32_16x16x32_bf16 v[236:239], v[140:143], v[160:163], v[236:239]
ds_read_b64_tr_b16 v[184:185], v6 offset:4096
ds_read_b64_tr_b16 v[186:187], v6 offset:4608
v_mfma_f32_16x16x32_bf16 v[236:239], v[144:147], v[164:167], v[236:239]
ds_read_b128 v[44:47], v1 offset:2176
v_mfma_f32_16x16x32_bf16 v[240:243], v[84:87], v[152:155], v[240:243]
ds_read_b128 v[12:15], v1 offset:4352
ds_read_b64_tr_b16 v[56:57], v6 offset:12288
v_mfma_f32_16x16x32_bf16 v[240:243], v[96:99], v[156:159], v[240:243]
ds_read_b64_tr_b16 v[58:59], v6 offset:12800
ds_read_b128 v[40:43], v1 offset:6528
v_mfma_f32_16x16x32_bf16 v[240:243], v[104:107], v[160:163], v[240:243]
ds_read_b128 v[52:55], v1 offset:8704
ds_read_b64_tr_b16 v[16:17], v5 offset:45056
v_mfma_f32_16x16x32_bf16 v[240:243], v[120:123], v[164:167], v[240:243]
s_waitcnt lgkmcnt(15)
ds_read_b64_tr_b16 v[18:19], v5 offset:45568
v_mfma_f32_16x16x32_bf16 v[240:243], v[128:131], v[168:171], v[240:243]
ds_read_b64_tr_b16 v[64:65], v5 offset:53248
ds_read_b64_tr_b16 v[66:67], v5 offset:53760
v_mfma_f32_16x16x32_bf16 v[244:247], v[132:135], v[152:155], v[244:247]
ds_read_b64_tr_b16 v[68:69], v6 offset:0
v_mfma_f32_16x16x32_bf16 v[244:247], v[116:119], v[156:159], v[244:247]
ds_read_b64_tr_b16 v[70:71], v6 offset:512
v_mfma_f32_16x16x32_bf16 v[244:247], v[136:139], v[160:163], v[244:247]
ds_read_b64_tr_b16 v[20:21], v6 offset:8192
v_mfma_f32_16x16x32_bf16 v[244:247], v[140:143], v[164:167], v[244:247]
ds_read_b64_tr_b16 v[22:23], v6 offset:8704
v_mfma_f32_16x16x32_bf16 v[244:247], v[144:147], v[168:171], v[244:247]
ds_read_b64_tr_b16 v[24:25], v6 offset:16384
v_mfma_f32_16x16x32_bf16 v[248:251], v[84:87], v[156:159], v[248:251]
ds_read_b64_tr_b16 v[26:27], v6 offset:16896
v_mfma_f32_16x16x32_bf16 v[248:251], v[96:99], v[160:163], v[248:251]
ds_read_b128 v[28:31], v1 offset:10880
v_mfma_f32_16x16x32_bf16 v[248:251], v[104:107], v[164:167], v[248:251]
v_mfma_f32_16x16x32_bf16 v[248:251], v[120:123], v[168:171], v[248:251]
v_mfma_f32_16x16x32_bf16 v[248:251], v[128:131], v[176:179], v[248:251]
v_mfma_f32_16x16x32_bf16 v[252:255], v[132:135], v[156:159], v[252:255]
v_mfma_f32_16x16x32_bf16 v[252:255], v[116:119], v[160:163], v[252:255]
v_mfma_f32_16x16x32_bf16 v[252:255], v[136:139], v[164:167], v[252:255]
v_mfma_f32_16x16x32_bf16 v[252:255], v[140:143], v[168:171], v[252:255]
v_mfma_f32_16x16x32_bf16 v[252:255], v[144:147], v[176:179], v[252:255]
s_waitcnt lgkmcnt(15)
v_mfma_f32_16x16x32_bf16 v[192:195], v[172:175], v[8:11], v[192:195]
ds_read_b128 v[32:35], v1 offset:13056
v_mfma_f32_16x16x32_bf16 v[192:195], v[180:183], v[44:47], v[192:195]
v_mfma_f32_16x16x32_bf16 v[192:195], v[188:191], v[12:15], v[192:195]
s_waitcnt lgkmcnt(13)
v_mfma_f32_16x16x32_bf16 v[192:195], v[184:187], v[40:43], v[192:195]
s_waitcnt lgkmcnt(12)
v_mfma_f32_16x16x32_bf16 v[192:195], v[56:59], v[52:55], v[192:195]
s_waitcnt lgkmcnt(10)
v_mfma_f32_16x16x32_bf16 v[196:199], v[16:19], v[8:11], v[196:199]
s_waitcnt lgkmcnt(8)
v_mfma_f32_16x16x32_bf16 v[196:199], v[64:67], v[44:47], v[196:199]
s_waitcnt lgkmcnt(6)
v_mfma_f32_16x16x32_bf16 v[196:199], v[68:71], v[12:15], v[196:199]
s_waitcnt lgkmcnt(4)
v_mfma_f32_16x16x32_bf16 v[196:199], v[20:23], v[40:43], v[196:199]
s_waitcnt lgkmcnt(2)
v_mfma_f32_16x16x32_bf16 v[196:199], v[24:27], v[52:55], v[196:199]
v_mfma_f32_16x16x32_bf16 v[200:203], v[172:175], v[44:47], v[200:203]
ds_read_b128 v[36:39], v1 offset:15232
v_mfma_f32_16x16x32_bf16 v[200:203], v[180:183], v[12:15], v[200:203]
v_mfma_f32_16x16x32_bf16 v[200:203], v[188:191], v[40:43], v[200:203]
v_mfma_f32_16x16x32_bf16 v[200:203], v[184:187], v[52:55], v[200:203]
s_waitcnt lgkmcnt(2)
v_mfma_f32_16x16x32_bf16 v[200:203], v[56:59], v[28:31], v[200:203]
v_mfma_f32_16x16x32_bf16 v[204:207], v[16:19], v[44:47], v[204:207]
s_barrier
v_mfma_f32_16x16x32_bf16 v[204:207], v[64:67], v[12:15], v[204:207]
v_mfma_f32_16x16x32_bf16 v[204:207], v[68:71], v[40:43], v[204:207]
v_mfma_f32_16x16x32_bf16 v[204:207], v[20:23], v[52:55], v[204:207]
v_mfma_f32_16x16x32_bf16 v[204:207], v[24:27], v[28:31], v[204:207]
v_mfma_f32_16x16x32_bf16 v[208:211], v[172:175], v[12:15], v[208:211]
ds_read_b128 v[48:51], v3 offset:0
v_mfma_f32_16x16x32_bf16 v[208:211], v[180:183], v[40:43], v[208:211]
ds_read_b64_tr_b16 v[76:77], v6 offset:20480
v_mfma_f32_16x16x32_bf16 v[208:211], v[188:191], v[52:55], v[208:211]
ds_read_b64_tr_b16 v[78:79], v6 offset:20992
v_mfma_f32_16x16x32_bf16 v[208:211], v[184:187], v[28:31], v[208:211]
s_waitcnt lgkmcnt(4)
v_mfma_f32_16x16x32_bf16 v[208:211], v[56:59], v[32:35], v[208:211]
v_mfma_f32_16x16x32_bf16 v[212:215], v[16:19], v[12:15], v[212:215]
ds_read_b64_tr_b16 v[60:61], v6 offset:28672
v_mfma_f32_16x16x32_bf16 v[212:215], v[64:67], v[40:43], v[212:215]
ds_read_b64_tr_b16 v[62:63], v6 offset:29184
v_mfma_f32_16x16x32_bf16 v[212:215], v[68:71], v[52:55], v[212:215]
v_mfma_f32_16x16x32_bf16 v[212:215], v[20:23], v[28:31], v[212:215]
v_mfma_f32_16x16x32_bf16 v[212:215], v[24:27], v[32:35], v[212:215]
v_mfma_f32_16x16x32_bf16 v[216:219], v[172:175], v[40:43], v[216:219]
ds_read_b128 v[80:83], v3 offset:2176
v_mfma_f32_16x16x32_bf16 v[216:219], v[180:183], v[52:55], v[216:219]
ds_read_b64_tr_b16 v[72:73], v6 offset:36864
v_mfma_f32_16x16x32_bf16 v[216:219], v[188:191], v[28:31], v[216:219]
ds_read_b64_tr_b16 v[74:75], v6 offset:37376
v_mfma_f32_16x16x32_bf16 v[216:219], v[184:187], v[32:35], v[216:219]
s_waitcnt lgkmcnt(8)
v_mfma_f32_16x16x32_bf16 v[216:219], v[56:59], v[36:39], v[216:219]
v_mfma_f32_16x16x32_bf16 v[220:223], v[16:19], v[40:43], v[220:223]
ds_read_b64_tr_b16 v[88:89], v6 offset:45056
v_mfma_f32_16x16x32_bf16 v[220:223], v[64:67], v[52:55], v[220:223]
ds_read_b64_tr_b16 v[90:91], v6 offset:45568
v_mfma_f32_16x16x32_bf16 v[220:223], v[68:71], v[28:31], v[220:223]
v_mfma_f32_16x16x32_bf16 v[220:223], v[20:23], v[32:35], v[220:223]
v_mfma_f32_16x16x32_bf16 v[220:223], v[24:27], v[36:39], v[220:223]
v_mfma_f32_16x16x32_bf16 v[224:227], v[172:175], v[52:55], v[224:227]
ds_read_b128 v[92:95], v3 offset:4352
v_mfma_f32_16x16x32_bf16 v[224:227], v[180:183], v[28:31], v[224:227]
ds_read_b64_tr_b16 v[100:101], v6 offset:53248
v_mfma_f32_16x16x32_bf16 v[224:227], v[188:191], v[32:35], v[224:227]
ds_read_b64_tr_b16 v[102:103], v6 offset:53760
v_mfma_f32_16x16x32_bf16 v[224:227], v[184:187], v[36:39], v[224:227]
s_waitcnt lgkmcnt(12)
v_mfma_f32_16x16x32_bf16 v[224:227], v[56:59], v[48:51], v[224:227]
v_mfma_f32_16x16x32_bf16 v[228:231], v[16:19], v[52:55], v[228:231]
ds_read_b64_tr_b16 v[108:109], v6 offset:24576
v_mfma_f32_16x16x32_bf16 v[228:231], v[64:67], v[28:31], v[228:231]
ds_read_b64_tr_b16 v[110:111], v6 offset:25088
v_mfma_f32_16x16x32_bf16 v[228:231], v[68:71], v[32:35], v[228:231]
v_mfma_f32_16x16x32_bf16 v[228:231], v[20:23], v[36:39], v[228:231]
v_mfma_f32_16x16x32_bf16 v[228:231], v[24:27], v[48:51], v[228:231]
v_mfma_f32_16x16x32_bf16 v[232:235], v[172:175], v[28:31], v[232:235]
ds_read_b128 v[112:115], v3 offset:6528
v_mfma_f32_16x16x32_bf16 v[232:235], v[180:183], v[32:35], v[232:235]
ds_read_b64_tr_b16 v[124:125], v6 offset:32768
v_mfma_f32_16x16x32_bf16 v[232:235], v[188:191], v[36:39], v[232:235]
ds_read_b64_tr_b16 v[126:127], v6 offset:33280
v_mfma_f32_16x16x32_bf16 v[232:235], v[184:187], v[48:51], v[232:235]
s_waitcnt lgkmcnt(12)
v_mfma_f32_16x16x32_bf16 v[232:235], v[56:59], v[80:83], v[232:235]
v_mfma_f32_16x16x32_bf16 v[236:239], v[16:19], v[28:31], v[236:239]
ds_read_b64_tr_b16 v[148:149], v6 offset:40960
v_mfma_f32_16x16x32_bf16 v[236:239], v[64:67], v[32:35], v[236:239]
ds_read_b64_tr_b16 v[150:151], v6 offset:41472
v_mfma_f32_16x16x32_bf16 v[236:239], v[68:71], v[36:39], v[236:239]
ds_read_b128 v[152:155], v2 offset:0
v_mfma_f32_16x16x32_bf16 v[236:239], v[20:23], v[48:51], v[236:239]
ds_read_b128 v[84:87], v2 offset:2176
v_mfma_f32_16x16x32_bf16 v[236:239], v[24:27], v[80:83], v[236:239]
ds_read_b128 v[96:99], v2 offset:4352
v_mfma_f32_16x16x32_bf16 v[240:243], v[172:175], v[32:35], v[240:243]
ds_read_b128 v[104:107], v2 offset:6528
v_mfma_f32_16x16x32_bf16 v[240:243], v[180:183], v[36:39], v[240:243]
ds_read_b128 v[120:123], v2 offset:8704
v_mfma_f32_16x16x32_bf16 v[240:243], v[188:191], v[48:51], v[240:243]
ds_read_b64_tr_b16 v[128:129], v6 offset:49152
ds_read_b64_tr_b16 v[130:131], v6 offset:49664
v_mfma_f32_16x16x32_bf16 v[240:243], v[184:187], v[80:83], v[240:243]
s_waitcnt lgkmcnt(15)
v_mfma_f32_16x16x32_bf16 v[240:243], v[56:59], v[92:95], v[240:243]
v_mfma_f32_16x16x32_bf16 v[244:247], v[16:19], v[32:35], v[244:247]
ds_read_b64_tr_b16 v[132:133], v6 offset:57344
v_mfma_f32_16x16x32_bf16 v[244:247], v[64:67], v[36:39], v[244:247]
ds_read_b64_tr_b16 v[134:135], v6 offset:57856
v_mfma_f32_16x16x32_bf16 v[244:247], v[68:71], v[48:51], v[244:247]
v_mfma_f32_16x16x32_bf16 v[244:247], v[20:23], v[80:83], v[244:247]
v_mfma_f32_16x16x32_bf16 v[244:247], v[24:27], v[92:95], v[244:247]
v_mfma_f32_16x16x32_bf16 v[248:251], v[172:175], v[36:39], v[248:251]
ds_read_b128 v[156:159], v2 offset:10880
v_mfma_f32_16x16x32_bf16 v[248:251], v[180:183], v[48:51], v[248:251]
v_mfma_f32_16x16x32_bf16 v[248:251], v[188:191], v[80:83], v[248:251]
v_mfma_f32_16x16x32_bf16 v[248:251], v[184:187], v[92:95], v[248:251]
s_waitcnt lgkmcnt(14)
v_mfma_f32_16x16x32_bf16 v[248:251], v[56:59], v[112:115], v[248:251]
v_mfma_f32_16x16x32_bf16 v[252:255], v[16:19], v[36:39], v[252:255]
v_mfma_f32_16x16x32_bf16 v[252:255], v[64:67], v[48:51], v[252:255]
v_mfma_f32_16x16x32_bf16 v[252:255], v[68:71], v[80:83], v[252:255]
v_mfma_f32_16x16x32_bf16 v[252:255], v[20:23], v[92:95], v[252:255]
v_mfma_f32_16x16x32_bf16 v[252:255], v[24:27], v[112:115], v[252:255]
s_waitcnt lgkmcnt(9)
v_mfma_f32_16x16x32_bf16 v[192:195], v[76:79], v[152:155], v[192:195]
s_waitcnt lgkmcnt(8)
ds_read_b128 v[116:119], v2 offset:13056
v_mfma_f32_16x16x32_bf16 v[192:195], v[60:63], v[84:87], v[192:195]
s_waitcnt lgkmcnt(8)
v_mfma_f32_16x16x32_bf16 v[192:195], v[72:75], v[96:99], v[192:195]
s_waitcnt lgkmcnt(7)
v_mfma_f32_16x16x32_bf16 v[192:195], v[88:91], v[104:107], v[192:195]
s_waitcnt lgkmcnt(6)
v_mfma_f32_16x16x32_bf16 v[192:195], v[100:103], v[120:123], v[192:195]
v_mfma_f32_16x16x32_bf16 v[196:199], v[108:111], v[152:155], v[196:199]
v_mfma_f32_16x16x32_bf16 v[196:199], v[124:127], v[84:87], v[196:199]
v_mfma_f32_16x16x32_bf16 v[196:199], v[148:151], v[96:99], v[196:199]
s_waitcnt lgkmcnt(4)
v_mfma_f32_16x16x32_bf16 v[196:199], v[128:131], v[104:107], v[196:199]
s_waitcnt lgkmcnt(2)
v_mfma_f32_16x16x32_bf16 v[196:199], v[132:135], v[120:123], v[196:199]
v_mfma_f32_16x16x32_bf16 v[200:203], v[76:79], v[84:87], v[200:203]
ds_read_b128 v[160:163], v2 offset:15232
v_mfma_f32_16x16x32_bf16 v[200:203], v[60:63], v[96:99], v[200:203]
v_mfma_f32_16x16x32_bf16 v[200:203], v[72:75], v[104:107], v[200:203]
v_mfma_f32_16x16x32_bf16 v[200:203], v[88:91], v[120:123], v[200:203]
s_waitcnt lgkmcnt(2)
v_mfma_f32_16x16x32_bf16 v[200:203], v[100:103], v[156:159], v[200:203]
v_mfma_f32_16x16x32_bf16 v[204:207], v[108:111], v[84:87], v[204:207]
v_mfma_f32_16x16x32_bf16 v[204:207], v[124:127], v[96:99], v[204:207]
v_mfma_f32_16x16x32_bf16 v[204:207], v[148:151], v[104:107], v[204:207]
v_mfma_f32_16x16x32_bf16 v[204:207], v[128:131], v[120:123], v[204:207]
v_mfma_f32_16x16x32_bf16 v[204:207], v[132:135], v[156:159], v[204:207]
v_mfma_f32_16x16x32_bf16 v[208:211], v[76:79], v[96:99], v[208:211]
v_mfma_f32_16x16x32_bf16 v[208:211], v[60:63], v[104:107], v[208:211]
v_mfma_f32_16x16x32_bf16 v[208:211], v[72:75], v[120:123], v[208:211]
v_mfma_f32_16x16x32_bf16 v[208:211], v[88:91], v[156:159], v[208:211]
s_waitcnt lgkmcnt(1)
v_mfma_f32_16x16x32_bf16 v[208:211], v[100:103], v[116:119], v[208:211]
v_mfma_f32_16x16x32_bf16 v[212:215], v[108:111], v[96:99], v[212:215]
s_barrier
v_mfma_f32_16x16x32_bf16 v[212:215], v[124:127], v[104:107], v[212:215]
ds_read_b64_tr_b16 v[136:137], v5 offset:0
v_mfma_f32_16x16x32_bf16 v[212:215], v[148:151], v[120:123], v[212:215]
ds_read_b64_tr_b16 v[138:139], v5 offset:512
v_mfma_f32_16x16x32_bf16 v[212:215], v[128:131], v[156:159], v[212:215]
ds_read_b128 v[164:167], v1 offset:17408
ds_read_b64_tr_b16 v[140:141], v5 offset:8192
v_mfma_f32_16x16x32_bf16 v[212:215], v[132:135], v[116:119], v[212:215]
ds_read_b64_tr_b16 v[142:143], v5 offset:8704
ds_read_b128 v[168:171], v1 offset:19584
v_mfma_f32_16x16x32_bf16 v[216:219], v[76:79], v[104:107], v[216:219]
ds_read_b64_tr_b16 v[144:145], v5 offset:16384
ds_read_b64_tr_b16 v[146:147], v5 offset:16896
v_mfma_f32_16x16x32_bf16 v[216:219], v[60:63], v[120:123], v[216:219]
ds_read_b128 v[176:179], v1 offset:21760
ds_read_b128 v[8:11], v1 offset:23936
v_mfma_f32_16x16x32_bf16 v[216:219], v[72:75], v[156:159], v[216:219]
ds_read_b128 v[44:47], v1 offset:26112
ds_read_b64_tr_b16 v[12:13], v5 offset:24576
v_mfma_f32_16x16x32_bf16 v[216:219], v[88:91], v[116:119], v[216:219]
s_waitcnt lgkmcnt(12)
ds_read_b64_tr_b16 v[14:15], v5 offset:25088
ds_read_b64_tr_b16 v[40:41], v5 offset:32768
v_mfma_f32_16x16x32_bf16 v[216:219], v[100:103], v[160:163], v[216:219]
ds_read_b64_tr_b16 v[42:43], v5 offset:33280
ds_read_b64_tr_b16 v[52:53], v5 offset:4096
v_mfma_f32_16x16x32_bf16 v[220:223], v[108:111], v[104:107], v[220:223]
ds_read_b64_tr_b16 v[54:55], v5 offset:4608
ds_read_b64_tr_b16 v[28:29], v5 offset:12288
v_mfma_f32_16x16x32_bf16 v[220:223], v[124:127], v[120:123], v[220:223]
ds_read_b64_tr_b16 v[30:31], v5 offset:12800
ds_read_b64_tr_b16 v[32:33], v5 offset:20480
v_mfma_f32_16x16x32_bf16 v[220:223], v[148:151], v[156:159], v[220:223]
ds_read_b64_tr_b16 v[34:35], v5 offset:20992
ds_read_b64_tr_b16 v[172:173], v5 offset:28672
v_mfma_f32_16x16x32_bf16 v[220:223], v[128:131], v[116:119], v[220:223]
ds_read_b64_tr_b16 v[174:175], v5 offset:29184
ds_read_b64_tr_b16 v[180:181], v5 offset:36864
v_mfma_f32_16x16x32_bf16 v[220:223], v[132:135], v[160:163], v[220:223]
s_waitcnt lgkmcnt(15)
ds_read_b64_tr_b16 v[182:183], v5 offset:37376
ds_read_b128 v[188:191], v1 offset:28288
v_mfma_f32_16x16x32_bf16 v[192:195], v[136:139], v[164:167], v[192:195]
ds_read_b128 v[184:187], v2 offset:17408
ds_read_b128 v[56:59], v2 offset:19584
v_mfma_f32_16x16x32_bf16 v[192:195], v[140:143], v[168:171], v[192:195]
ds_read_b128 v[16:19], v2 offset:21760
ds_read_b128 v[36:39], v2 offset:23936
v_mfma_f32_16x16x32_bf16 v[192:195], v[144:147], v[176:179], v[192:195]
s_waitcnt lgkmcnt(15)
ds_read_b128 v[64:67], v2 offset:26112
v_mfma_f32_16x16x32_bf16 v[192:195], v[12:15], v[8:11], v[192:195]
v_mfma_f32_16x16x32_bf16 v[192:195], v[40:43], v[44:47], v[192:195]
s_waitcnt lgkmcnt(14)
v_mfma_f32_16x16x32_bf16 v[196:199], v[52:55], v[164:167], v[196:199]
s_waitcnt lgkmcnt(12)
v_mfma_f32_16x16x32_bf16 v[196:199], v[28:31], v[168:171], v[196:199]
s_waitcnt lgkmcnt(10)
v_mfma_f32_16x16x32_bf16 v[196:199], v[32:35], v[176:179], v[196:199]
s_waitcnt lgkmcnt(8)
v_mfma_f32_16x16x32_bf16 v[196:199], v[172:175], v[8:11], v[196:199]
s_waitcnt lgkmcnt(6)
v_mfma_f32_16x16x32_bf16 v[196:199], v[180:183], v[44:47], v[196:199]
v_mfma_f32_16x16x32_bf16 v[200:203], v[136:139], v[168:171], v[200:203]
s_barrier
v_mfma_f32_16x16x32_bf16 v[200:203], v[140:143], v[176:179], v[200:203]
ds_read_b128 v[48:51], v2 offset:28288
v_mfma_f32_16x16x32_bf16 v[200:203], v[144:147], v[8:11], v[200:203]
ds_read_b64_tr_b16 v[68:69], v5 offset:40960
v_mfma_f32_16x16x32_bf16 v[200:203], v[12:15], v[44:47], v[200:203]
s_waitcnt lgkmcnt(7)
ds_read_b64_tr_b16 v[70:71], v5 offset:41472
ds_read_b64_tr_b16 v[80:81], v5 offset:49152
v_mfma_f32_16x16x32_bf16 v[200:203], v[40:43], v[188:191], v[200:203]
ds_read_b64_tr_b16 v[82:83], v5 offset:49664
ds_read_b64_tr_b16 v[20:21], v5 offset:57344
v_mfma_f32_16x16x32_bf16 v[204:207], v[52:55], v[168:171], v[204:207]
ds_read_b64_tr_b16 v[22:23], v5 offset:57856
ds_read_b64_tr_b16 v[92:93], v6 offset:4096
v_mfma_f32_16x16x32_bf16 v[204:207], v[28:31], v[176:179], v[204:207]
ds_read_b64_tr_b16 v[94:95], v6 offset:4608
ds_read_b64_tr_b16 v[24:25], v6 offset:12288
v_mfma_f32_16x16x32_bf16 v[204:207], v[32:35], v[8:11], v[204:207]
ds_read_b64_tr_b16 v[26:27], v6 offset:12800
ds_read_b64_tr_b16 v[112:113], v5 offset:45056
v_mfma_f32_16x16x32_bf16 v[204:207], v[172:175], v[44:47], v[204:207]
ds_read_b64_tr_b16 v[114:115], v5 offset:45568
ds_read_b64_tr_b16 v[152:153], v5 offset:53248
v_mfma_f32_16x16x32_bf16 v[204:207], v[180:183], v[188:191], v[204:207]
s_waitcnt lgkmcnt(11)
ds_read_b64_tr_b16 v[154:155], v5 offset:53760
ds_read_b64_tr_b16 v[84:85], v6 offset:0
v_mfma_f32_16x16x32_bf16 v[192:195], v[68:71], v[184:187], v[192:195]
s_waitcnt lgkmcnt(11)
ds_read_b64_tr_b16 v[86:87], v6 offset:512
ds_read_b64_tr_b16 v[96:97], v6 offset:8192
v_mfma_f32_16x16x32_bf16 v[192:195], v[80:83], v[56:59], v[192:195]
s_waitcnt lgkmcnt(11)
ds_read_b64_tr_b16 v[98:99], v6 offset:8704
ds_read_b64_tr_b16 v[104:105], v6 offset:16384
v_mfma_f32_16x16x32_bf16 v[192:195], v[20:23], v[16:19], v[192:195]
s_waitcnt lgkmcnt(11)
ds_read_b64_tr_b16 v[106:107], v6 offset:16896
ds_read_b128 v[120:123], v1 offset:30464
v_mfma_f32_16x16x32_bf16 v[192:195], v[92:95], v[36:39], v[192:195]
s_waitcnt lgkmcnt(11)
v_mfma_f32_16x16x32_bf16 v[192:195], v[24:27], v[64:67], v[192:195]
s_waitcnt lgkmcnt(9)
v_mfma_f32_16x16x32_bf16 v[196:199], v[112:115], v[184:187], v[196:199]
s_waitcnt lgkmcnt(7)
ds_read_b128 v[156:159], v2 offset:30464
v_mfma_f32_16x16x32_bf16 v[196:199], v[152:155], v[56:59], v[196:199]
s_waitcnt lgkmcnt(6)
v_mfma_f32_16x16x32_bf16 v[196:199], v[84:87], v[16:19], v[196:199]
s_waitcnt lgkmcnt(4)
v_mul_f32 v192, s32, v192
v_mul_f32 v193, s32, v193
v_mfma_f32_16x16x32_bf16 v[196:199], v[96:99], v[36:39], v[196:199]
s_waitcnt lgkmcnt(2)
v_mul_f32 v194, s32, v194
v_mul_f32 v195, s32, v195
v_mfma_f32_16x16x32_bf16 v[196:199], v[104:107], v[64:67], v[196:199]
v_min_f32 v192, s28, v192
v_min_f32 v193, s28, v193
v_mfma_f32_16x16x32_bf16 v[200:203], v[68:71], v[56:59], v[200:203]
v_exp_f32 v192, v192
v_mfma_f32_16x16x32_bf16 v[200:203], v[80:83], v[16:19], v[200:203]
v_exp_f32 v193, v193
v_mfma_f32_16x16x32_bf16 v[200:203], v[20:23], v[36:39], v[200:203]
v_min_f32 v194, s28, v194
v_mul_f32 v196, s34, v196
v_mfma_f32_16x16x32_bf16 v[200:203], v[92:95], v[64:67], v[200:203]
v_exp_f32 v196, v196
v_mfma_f32_16x16x32_bf16 v[200:203], v[24:27], v[48:51], v[200:203]
v_exp_f32 v194, v194
v_mfma_f32_16x16x32_bf16 v[204:207], v[112:115], v[56:59], v[204:207]
v_mul_f32 v197, s34, v197
v_mul_f32 v198, s34, v198
v_mfma_f32_16x16x32_bf16 v[204:207], v[152:155], v[16:19], v[204:207]
v_exp_f32 v197, v197
v_mfma_f32_16x16x32_bf16 v[204:207], v[84:87], v[36:39], v[204:207]
v_exp_f32 v198, v198
v_mfma_f32_16x16x32_bf16 v[204:207], v[96:99], v[64:67], v[204:207]
v_mul_f32 v199, s34, v199
v_min_f32 v195, s28, v195
v_mfma_f32_16x16x32_bf16 v[204:207], v[104:107], v[48:51], v[204:207]
v_exp_f32 v199, v199
v_mfma_f32_16x16x32_bf16 v[208:211], v[136:139], v[176:179], v[208:211]
ds_read_b128 v[116:119], v1 offset:32640
v_add_f32 v196, 1.0, v196
v_mfma_f32_16x16x32_bf16 v[208:211], v[140:143], v[8:11], v[208:211]
v_exp_f32 v195, v195
v_mfma_f32_16x16x32_bf16 v[208:211], v[144:147], v[44:47], v[208:211]
v_add_f32 v197, 1.0, v197
v_add_f32 v198, 1.0, v198
v_mfma_f32_16x16x32_bf16 v[208:211], v[12:15], v[188:191], v[208:211]
s_waitcnt lgkmcnt(2)
v_add_f32 v199, 1.0, v199
v_fma_f32 v196, v192, v196, v196
v_mfma_f32_16x16x32_bf16 v[208:211], v[40:43], v[120:123], v[208:211]
v_rcp_f32 v196, v196
v_mfma_f32_16x16x32_bf16 v[208:211], v[68:71], v[16:19], v[208:211]
ds_read_b128 v[160:163], v2 offset:32640
v_fma_f32 v197, v193, v197, v197
v_mfma_f32_16x16x32_bf16 v[208:211], v[80:83], v[36:39], v[208:211]
v_rcp_f32 v197, v197
v_mfma_f32_16x16x32_bf16 v[208:211], v[20:23], v[64:67], v[208:211]
v_fma_f32 v198, v194, v198, v198
v_fma_f32 v199, v195, v199, v199
v_mfma_f32_16x16x32_bf16 v[208:211], v[92:95], v[48:51], v[208:211]
s_waitcnt lgkmcnt(2)
v_rcp_f32 v198, v198
v_mfma_f32_16x16x32_bf16 v[208:211], v[24:27], v[156:159], v[208:211]
v_rcp_f32 v199, v199
v_mfma_f32_16x16x32_bf16 v[212:215], v[52:55], v[176:179], v[212:215]
v_fma_f32 v192, v192, v196, -v196
v_fma_f32 v193, v193, v197, -v197
v_mfma_f32_16x16x32_bf16 v[212:215], v[28:31], v[8:11], v[212:215]
v_fma_f32 v194, v194, v198, -v198
v_fma_f32 v195, v195, v199, -v199
L_touch1:
s_cbranch_scc1 L_back
v_mfma_f32_16x16x32_bf16 v[212:215], v[32:35], v[44:47], v[212:215]
v_cvt_pk_bf16_f32 v192, v192, v193
v_cvt_pk_bf16_f32 v193, v194, v195
v_mfma_f32_16x16x32_bf16 v[212:215], v[172:175], v[188:191], v[212:215]
ds_write_b64 v7, v[192:193] offset:0
v_mul_f32 v200, s32, v200
v_mfma_f32_16x16x32_bf16 v[212:215], v[180:183], v[120:123], v[212:215]
v_mul_f32 v201, s32, v201
v_mul_f32 v202, s32, v202
v_mfma_f32_16x16x32_bf16 v[212:215], v[112:115], v[16:19], v[212:215]
v_mul_f32 v203, s32, v203
v_mul_f32 v204, s34, v204
v_mfma_f32_16x16x32_bf16 v[212:215], v[152:155], v[36:39], v[212:215]
ds_read_b128 v[164:167], v2 offset:8704
v_mul_f32 v205, s34, v205
v_mfma_f32_16x16x32_bf16 v[212:215], v[84:87], v[64:67], v[212:215]
ds_read_b128 v[168:171], v2 offset:10880
v_mul_f32 v206, s34, v206
v_mfma_f32_16x16x32_bf16 v[212:215], v[96:99], v[48:51], v[212:215]
ds_read_b128 v[184:187], v2 offset:13056
v_mul_f32 v207, s34, v207
v_mfma_f32_16x16x32_bf16 v[212:215], v[104:107], v[156:159], v[212:215]
ds_read_b128 v[56:59], v2 offset:15232
v_min_f32 v200, s28, v200
v_mfma_f32_16x16x32_bf16 v[216:219], v[136:139], v[8:11], v[216:219]
ds_read_b128 v[176:179], v4 offset:0
v_min_f32 v201, s28, v201
v_mfma_f32_16x16x32_bf16 v[216:219], v[140:143], v[44:47], v[216:219]
v_exp_f32 v204, v204
v_mfma_f32_16x16x32_bf16 v[216:219], v[144:147], v[188:191], v[216:219]
v_exp_f32 v205, v205
v_mfma_f32_16x16x32_bf16 v[216:219], v[12:15], v[120:123], v[216:219]
s_waitcnt lgkmcnt(7)
v_exp_f32 v206, v206
v_mfma_f32_16x16x32_bf16 v[216:219], v[40:43], v[116:119], v[216:219]
v_exp_f32 v207, v207
v_mfma_f32_16x16x32_bf16 v[216:219], v[68:71], v[36:39], v[216:219]
v_exp_f32 v200, v200
v_mfma_f32_16x16x32_bf16 v[216:219], v[80:83], v[64:67], v[216:219]
v_exp_f32 v201, v201
v_mfma_f32_16x16x32_bf16 v[216:219], v[20:23], v[48:51], v[216:219]
v_min_f32 v202, s28, v202
v_min_f32 v203, s28, v203
v_mfma_f32_16x16x32_bf16 v[216:219], v[92:95], v[156:159], v[216:219]
s_waitcnt lgkmcnt(6)
v_exp_f32 v202, v202
v_mfma_f32_16x16x32_bf16 v[216:219], v[24:27], v[160:163], v[216:219]
v_exp_f32 v203, v203
v_mfma_f32_16x16x32_bf16 v[220:223], v[52:55], v[8:11], v[220:223]
ds_read_b128 v[196:199], v4 offset:2176
v_add_f32 v204, 1.0, v204
v_mfma_f32_16x16x32_bf16 v[220:223], v[28:31], v[44:47], v[220:223]
v_add_f32 v205, 1.0, v205
v_add_f32 v206, 1.0, v206
v_mfma_f32_16x16x32_bf16 v[220:223], v[32:35], v[188:191], v[220:223]
v_add_f32 v207, 1.0, v207
v_fma_f32 v204, v200, v204, v204
v_mfma_f32_16x16x32_bf16 v[220:223], v[172:175], v[120:123], v[220:223]
v_rcp_f32 v204, v204
v_mfma_f32_16x16x32_bf16 v[220:223], v[180:183], v[116:119], v[220:223]
v_fma_f32 v205, v201, v205, v205
v_fma_f32 v206, v202, v206, v206
v_mfma_f32_16x16x32_bf16 v[220:223], v[112:115], v[36:39], v[220:223]
v_rcp_f32 v205, v205
v_mfma_f32_16x16x32_bf16 v[220:223], v[152:155], v[64:67], v[220:223]
v_rcp_f32 v206, v206
v_mfma_f32_16x16x32_bf16 v[220:223], v[84:87], v[48:51], v[220:223]
v_fma_f32 v207, v203, v207, v207
v_fma_f32 v200, v200, v204, -v204
v_mfma_f32_16x16x32_bf16 v[220:223], v[96:99], v[156:159], v[220:223]
v_rcp_f32 v207, v207
v_mfma_f32_16x16x32_bf16 v[220:223], v[104:107], v[160:163], v[220:223]
s_waitcnt lgkmcnt(5)
v_fma_f32 v201, v201, v205, -v205
v_fma_f32 v202, v202, v206, -v206
v_mfma_f32_16x16x32_bf16 v[224:227], v[76:79], v[164:167], v[224:227]
s_waitcnt lgkmcnt(4)
ds_read_b128 v[16:19], v3 offset:17408
v_fma_f32 v203, v203, v207, -v207
v_mfma_f32_16x16x32_bf16 v[224:227], v[60:63], v[168:171], v[224:227]
s_waitcnt lgkmcnt(4)
v_cvt_pk_bf16_f32 v200, v200, v201
v_cvt_pk_bf16_f32 v201, v202, v203
v_mfma_f32_16x16x32_bf16 v[224:227], v[72:75], v[184:187], v[224:227]
s_waitcnt lgkmcnt(3)
ds_write_b64 v7, v[200:201] offset:2048
v_mul_f32 v208, s32, v208
v_mfma_f32_16x16x32_bf16 v[224:227], v[88:91], v[56:59], v[224:227]
s_waitcnt lgkmcnt(3)
v_mul_f32 v209, s32, v209
v_mul_f32 v210, s32, v210
v_mfma_f32_16x16x32_bf16 v[224:227], v[100:103], v[176:179], v[224:227]
v_mul_f32 v211, s32, v211
v_mul_f32 v212, s34, v212
v_mfma_f32_16x16x32_bf16 v[228:231], v[108:111], v[164:167], v[228:231]
ds_read_b128 v[8:11], v4 offset:17408
v_mul_f32 v213, s34, v213
v_mfma_f32_16x16x32_bf16 v[228:231], v[124:127], v[168:171], v[228:231]
v_exp_f32 v212, v212
v_mfma_f32_16x16x32_bf16 v[228:231], v[148:151], v[184:187], v[228:231]
s_waitcnt lgkmcnt(1)
s_barrier
v_mfma_f32_16x16x32_bf16 v[228:231], v[128:131], v[56:59], v[228:231]
v_exp_f32 v213, v213
v_mfma_f32_16x16x32_bf16 v[228:231], v[132:135], v[176:179], v[228:231]
v_mul_f32 v214, s34, v214
v_mul_f32 v215, s34, v215
v_mfma_f32_16x16x32_bf16 v[232:235], v[76:79], v[168:171], v[232:235]
v_exp_f32 v214, v214
v_mfma_f32_16x16x32_bf16 v[232:235], v[60:63], v[184:187], v[232:235]
v_exp_f32 v215, v215
v_mfma_f32_16x16x32_bf16 v[232:235], v[72:75], v[56:59], v[232:235]
v_min_f32 v208, s28, v208
v_min_f32 v209, s28, v209
v_mfma_f32_16x16x32_bf16 v[232:235], v[88:91], v[176:179], v[232:235]
v_exp_f32 v208, v208
v_mfma_f32_16x16x32_bf16 v[232:235], v[100:103], v[196:199], v[232:235]
v_exp_f32 v209, v209
v_mfma_f32_16x16x32_bf16 v[236:239], v[108:111], v[168:171], v[236:239]
v_min_f32 v210, s28, v210
v_min_f32 v211, s28, v211
v_mfma_f32_16x16x32_bf16 v[236:239], v[124:127], v[184:187], v[236:239]
v_exp_f32 v210, v210
v_mfma_f32_16x16x32_bf16 v[236:239], v[148:151], v[56:59], v[236:239]
v_exp_f32 v211, v211
v_mfma_f32_16x16x32_bf16 v[236:239], v[128:131], v[176:179], v[236:239]
v_add_f32 v212, 1.0, v212
v_add_f32 v213, 1.0, v213
v_mfma_f32_16x16x32_bf16 v[236:239], v[132:135], v[196:199], v[236:239]
v_add_f32 v214, 1.0, v214
v_add_f32 v215, 1.0, v215
v_mfma_f32_16x16x32_bf16 v[224:227], v[136:139], v[44:47], v[224:227]
ds_read_b128 v[36:39], v3 offset:19584
v_fma_f32 v212, v208, v212, v212
v_mfma_f32_16x16x32_bf16 v[224:227], v[140:143], v[188:191], v[224:227]
v_rcp_f32 v212, v212
v_mfma_f32_16x16x32_bf16 v[224:227], v[144:147], v[120:123], v[224:227]
v_fma_f32 v213, v209, v213, v213
v_fma_f32 v214, v210, v214, v214
v_mfma_f32_16x16x32_bf16 v[224:227], v[12:15], v[116:119], v[224:227]
v_rcp_f32 v213, v213
v_mfma_f32_16x16x32_bf16 v[224:227], v[40:43], v[16:19], v[224:227]
v_rcp_f32 v214, v214
v_mfma_f32_16x16x32_bf16 v[224:227], v[68:71], v[64:67], v[224:227]
ds_read_b128 v[192:195], v4 offset:19584
v_fma_f32 v215, v211, v215, v215
v_mfma_f32_16x16x32_bf16 v[224:227], v[80:83], v[48:51], v[224:227]
v_rcp_f32 v215, v215
v_mfma_f32_16x16x32_bf16 v[224:227], v[20:23], v[156:159], v[224:227]
v_fma_f32 v208, v208, v212, -v212
v_fma_f32 v209, v209, v213, -v213
v_mfma_f32_16x16x32_bf16 v[224:227], v[92:95], v[160:163], v[224:227]
s_waitcnt lgkmcnt(2)
v_fma_f32 v210, v210, v214, -v214
v_fma_f32 v211, v211, v215, -v215
v_mfma_f32_16x16x32_bf16 v[224:227], v[24:27], v[8:11], v[224:227]
v_cvt_pk_bf16_f32 v208, v208, v209
v_cvt_pk_bf16_f32 v209, v210, v211
v_mfma_f32_16x16x32_bf16 v[228:231], v[52:55], v[44:47], v[228:231]
ds_write_b64 v7, v[208:209] offset:4096
v_mul_f32 v216, s32, v216
v_mfma_f32_16x16x32_bf16 v[228:231], v[28:31], v[188:191], v[228:231]
v_mul_f32 v217, s32, v217
v_mul_f32 v218, s32, v218
v_mfma_f32_16x16x32_bf16 v[228:231], v[32:35], v[120:123], v[228:231]
v_mul_f32 v219, s32, v219
v_mul_f32 v220, s34, v220
v_mfma_f32_16x16x32_bf16 v[228:231], v[172:175], v[116:119], v[228:231]
v_exp_f32 v220, v220
v_mfma_f32_16x16x32_bf16 v[228:231], v[180:183], v[16:19], v[228:231]
v_mul_f32 v221, s34, v221
v_mul_f32 v222, s34, v222
v_mfma_f32_16x16x32_bf16 v[228:231], v[112:115], v[64:67], v[228:231]
v_exp_f32 v221, v221
v_mfma_f32_16x16x32_bf16 v[228:231], v[152:155], v[48:51], v[228:231]
v_exp_f32 v222, v222
v_mfma_f32_16x16x32_bf16 v[228:231], v[84:87], v[156:159], v[228:231]
v_mul_f32 v223, s34, v223
v_min_f32 v216, s28, v216
v_mfma_f32_16x16x32_bf16 v[228:231], v[96:99], v[160:163], v[228:231]
v_exp_f32 v223, v223
v_mfma_f32_16x16x32_bf16 v[228:231], v[104:107], v[8:11], v[228:231]
v_exp_f32 v216, v216
v_mfma_f32_16x16x32_bf16 v[232:235], v[136:139], v[188:191], v[232:235]
ds_read_b128 v[204:207], v4 offset:4352
v_min_f32 v217, s28, v217
v_mfma_f32_16x16x32_bf16 v[232:235], v[140:143], v[120:123], v[232:235]
v_exp_f32 v217, v217
v_mfma_f32_16x16x32_bf16 v[232:235], v[144:147], v[116:119], v[232:235]
v_min_f32 v218, s28, v218
v_min_f32 v219, s28, v219
v_mfma_f32_16x16x32_bf16 v[232:235], v[12:15], v[16:19], v[232:235]
s_waitcnt lgkmcnt(3)
v_exp_f32 v218, v218
v_mfma_f32_16x16x32_bf16 v[232:235], v[40:43], v[36:39], v[232:235]
v_exp_f32 v219, v219
v_mfma_f32_16x16x32_bf16 v[232:235], v[68:71], v[48:51], v[232:235]
ds_read_b128 v[164:167], v3 offset:21760
v_add_f32 v220, 1.0, v220
v_mfma_f32_16x16x32_bf16 v[232:235], v[80:83], v[156:159], v[232:235]
v_add_f32 v221, 1.0, v221
v_add_f32 v222, 1.0, v222
v_mfma_f32_16x16x32_bf16 v[232:235], v[20:23], v[160:163], v[232:235]
v_add_f32 v223, 1.0, v223
v_fma_f32 v220, v216, v220, v220
v_mfma_f32_16x16x32_bf16 v[232:235], v[92:95], v[8:11], v[232:235]
s_waitcnt lgkmcnt(3)
v_rcp_f32 v220, v220
v_mfma_f32_16x16x32_bf16 v[232:235], v[24:27], v[192:195], v[232:235]
v_fma_f32 v221, v217, v221, v221
v_fma_f32 v222, v218, v222, v222
v_mfma_f32_16x16x32_bf16 v[236:239], v[52:55], v[188:191], v[236:239]
ds_read_b128 v[200:203], v4 offset:21760
v_fma_f32 v223, v219, v223, v223
v_mfma_f32_16x16x32_bf16 v[236:239], v[28:31], v[120:123], v[236:239]
v_rcp_f32 v221, v221
v_mfma_f32_16x16x32_bf16 v[236:239], v[32:35], v[116:119], v[236:239]
v_rcp_f32 v222, v222
v_mfma_f32_16x16x32_bf16 v[236:239], v[172:175], v[16:19], v[236:239]
v_rcp_f32 v223, v223
v_mfma_f32_16x16x32_bf16 v[236:239], v[180:183], v[36:39], v[236:239]
v_fma_f32 v216, v216, v220, -v220
v_fma_f32 v217, v217, v221, -v221
v_mfma_f32_16x16x32_bf16 v[236:239], v[112:115], v[48:51], v[236:239]
v_fma_f32 v218, v218, v222, -v222
v_fma_f32 v219, v219, v223, -v223
v_mfma_f32_16x16x32_bf16 v[236:239], v[152:155], v[156:159], v[236:239]
v_cvt_pk_bf16_f32 v216, v216, v217
v_cvt_pk_bf16_f32 v217, v218, v219
v_mfma_f32_16x16x32_bf16 v[236:239], v[84:87], v[160:163], v[236:239]
ds_write_b64 v7, v[216:217] offset:6144
v_mul_f32 v224, s32, v224
v_mfma_f32_16x16x32_bf16 v[236:239], v[96:99], v[8:11], v[236:239]
v_mul_f32 v225, s32, v225
v_mul_f32 v226, s32, v226
v_mfma_f32_16x16x32_bf16 v[236:239], v[104:107], v[192:195], v[236:239]
v_mul_f32 v227, s32, v227
v_mul_f32 v228, s34, v228
v_mfma_f32_16x16x32_bf16 v[240:243], v[76:79], v[184:187], v[240:243]
v_exp_f32 v228, v228
v_mfma_f32_16x16x32_bf16 v[240:243], v[60:63], v[56:59], v[240:243]
v_mul_f32 v229, s34, v229
v_mul_f32 v230, s34, v230
v_mfma_f32_16x16x32_bf16 v[240:243], v[72:75], v[176:179], v[240:243]
s_waitcnt lgkmcnt(0)
s_barrier
v_mfma_f32_16x16x32_bf16 v[240:243], v[88:91], v[196:199], v[240:243]
v_exp_f32 v229, v229
v_mfma_f32_16x16x32_bf16 v[240:243], v[100:103], v[204:207], v[240:243]
v_exp_f32 v230, v230
v_mfma_f32_16x16x32_bf16 v[240:243], v[136:139], v[120:123], v[240:243]
v_mul_f32 v231, s34, v231
v_min_f32 v224, s28, v224
v_mfma_f32_16x16x32_bf16 v[240:243], v[140:143], v[116:119], v[240:243]
v_exp_f32 v231, v231
v_mfma_f32_16x16x32_bf16 v[240:243], v[144:147], v[16:19], v[240:243]
v_exp_f32 v224, v224
v_mfma_f32_16x16x32_bf16 v[240:243], v[12:15], v[36:39], v[240:243]
v_min_f32 v225, s28, v225
v_min_f32 v226, s28, v226
v_mfma_f32_16x16x32_bf16 v[240:243], v[40:43], v[164:167], v[240:243]
v_exp_f32 v225, v225
v_mfma_f32_16x16x32_bf16 v[240:243], v[68:71], v[156:159], v[240:243]
ds_read_b128 v[168:171], v4 offset:6528
v_min_f32 v227, s28, v227
v_mfma_f32_16x16x32_bf16 v[240:243], v[80:83], v[160:163], v[240:243]
v_exp_f32 v226, v226
v_mfma_f32_16x16x32_bf16 v[240:243], v[20:23], v[8:11], v[240:243]
v_exp_f32 v227, v227
v_mfma_f32_16x16x32_bf16 v[240:243], v[92:95], v[192:195], v[240:243]
v_add_f32 v228, 1.0, v228
v_add_f32 v229, 1.0, v229
v_mfma_f32_16x16x32_bf16 v[240:243], v[24:27], v[200:203], v[240:243]
v_add_f32 v230, 1.0, v230
v_add_f32 v231, 1.0, v231
v_mfma_f32_16x16x32_bf16 v[244:247], v[108:111], v[184:187], v[244:247]
ds_read_b128 v[212:215], v3 offset:23936
v_fma_f32 v228, v224, v228, v228
v_mfma_f32_16x16x32_bf16 v[244:247], v[124:127], v[56:59], v[244:247]
v_rcp_f32 v228, v228
v_mfma_f32_16x16x32_bf16 v[244:247], v[148:151], v[176:179], v[244:247]
v_fma_f32 v229, v225, v229, v229
v_fma_f32 v230, v226, v230, v230
v_mfma_f32_16x16x32_bf16 v[244:247], v[128:131], v[196:199], v[244:247]
v_rcp_f32 v229, v229
v_mfma_f32_16x16x32_bf16 v[244:247], v[132:135], v[204:207], v[244:247]
v_rcp_f32 v230, v230
v_mfma_f32_16x16x32_bf16 v[244:247], v[52:55], v[120:123], v[244:247]
ds_read_b128 v[44:47], v4 offset:23936
v_fma_f32 v231, v227, v231, v231
v_mfma_f32_16x16x32_bf16 v[244:247], v[28:31], v[116:119], v[244:247]
v_rcp_f32 v231, v231
v_mfma_f32_16x16x32_bf16 v[244:247], v[32:35], v[16:19], v[244:247]
v_fma_f32 v224, v224, v228, -v228
v_fma_f32 v225, v225, v229, -v229
v_mfma_f32_16x16x32_bf16 v[244:247], v[172:175], v[36:39], v[244:247]
v_fma_f32 v226, v226, v230, -v230
v_fma_f32 v227, v227, v231, -v231
v_mfma_f32_16x16x32_bf16 v[244:247], v[180:183], v[164:167], v[244:247]
v_cvt_pk_bf16_f32 v224, v224, v225
v_cvt_pk_bf16_f32 v225, v226, v227
v_mfma_f32_16x16x32_bf16 v[244:247], v[112:115], v[156:159], v[244:247]
ds_write_b64 v7, v[224:225] offset:8192
v_mul_f32 v232, s32, v232
v_mfma_f32_16x16x32_bf16 v[244:247], v[152:155], v[160:163], v[244:247]
v_mul_f32 v233, s32, v233
v_mul_f32 v234, s32, v234
v_mfma_f32_16x16x32_bf16 v[244:247], v[84:87], v[8:11], v[244:247]
v_mul_f32 v235, s32, v235
v_mul_f32 v236, s34, v236
v_mfma_f32_16x16x32_bf16 v[244:247], v[96:99], v[192:195], v[244:247]
v_exp_f32 v236, v236
v_mfma_f32_16x16x32_bf16 v[244:247], v[104:107], v[200:203], v[244:247]
v_mul_f32 v237, s34, v237
v_mul_f32 v238, s34, v238
v_mfma_f32_16x16x32_bf16 v[248:251], v[76:79], v[56:59], v[248:251]
v_exp_f32 v237, v237
v_mfma_f32_16x16x32_bf16 v[248:251], v[60:63], v[176:179], v[248:251]
v_exp_f32 v238, v238
v_mfma_f32_16x16x32_bf16 v[248:251], v[72:75], v[196:199], v[248:251]
v_mul_f32 v239, s34, v239
v_min_f32 v232, s28, v232
v_mfma_f32_16x16x32_bf16 v[248:251], v[88:91], v[204:207], v[248:251]
s_waitcnt lgkmcnt(3)
v_exp_f32 v239, v239
v_mfma_f32_16x16x32_bf16 v[248:251], v[100:103], v[168:171], v[248:251]
v_exp_f32 v232, v232
v_mfma_f32_16x16x32_bf16 v[248:251], v[136:139], v[116:119], v[248:251]
v_min_f32 v233, s28, v233
v_min_f32 v234, s28, v234
v_mfma_f32_16x16x32_bf16 v[248:251], v[140:143], v[16:19], v[248:251]
v_exp_f32 v233, v233
v_mfma_f32_16x16x32_bf16 v[248:251], v[144:147], v[36:39], v[248:251]
v_exp_f32 v234, v234
v_mfma_f32_16x16x32_bf16 v[248:251], v[12:15], v[164:167], v[248:251]
s_waitcnt lgkmcnt(2)
v_min_f32 v235, s28, v235
v_add_f32 v236, 1.0, v236
v_mfma_f32_16x16x32_bf16 v[248:251], v[40:43], v[212:215], v[248:251]
v_exp_f32 v235, v235
v_mfma_f32_16x16x32_bf16 v[248:251], v[68:71], v[160:163], v[248:251]
v_add_f32 v237, 1.0, v237
v_add_f32 v238, 1.0, v238
v_mfma_f32_16x16x32_bf16 v[248:251], v[80:83], v[8:11], v[248:251]
v_add_f32 v239, 1.0, v239
v_fma_f32 v236, v232, v236, v236
v_mfma_f32_16x16x32_bf16 v[248:251], v[20:23], v[192:195], v[248:251]
v_rcp_f32 v236, v236
v_mfma_f32_16x16x32_bf16 v[248:251], v[92:95], v[200:203], v[248:251]
s_waitcnt lgkmcnt(1)
v_fma_f32 v237, v233, v237, v237
v_fma_f32 v238, v234, v238, v238
v_mfma_f32_16x16x32_bf16 v[248:251], v[24:27], v[44:47], v[248:251]
v_rcp_f32 v237, v237
v_mfma_f32_16x16x32_bf16 v[252:255], v[108:111], v[56:59], v[252:255]
v_rcp_f32 v238, v238
v_mfma_f32_16x16x32_bf16 v[252:255], v[124:127], v[176:179], v[252:255]
v_fma_f32 v239, v235, v239, v239
v_fma_f32 v232, v232, v236, -v236
v_mfma_f32_16x16x32_bf16 v[252:255], v[148:151], v[196:199], v[252:255]
v_rcp_f32 v239, v239
v_mfma_f32_16x16x32_bf16 v[252:255], v[128:131], v[204:207], v[252:255]
v_fma_f32 v233, v233, v237, -v237
v_fma_f32 v234, v234, v238, -v238
v_mfma_f32_16x16x32_bf16 v[252:255], v[132:135], v[168:171], v[252:255]
v_fma_f32 v235, v235, v239, -v239
v_cvt_pk_bf16_f32 v232, v232, v233
v_mfma_f32_16x16x32_bf16 v[252:255], v[52:55], v[116:119], v[252:255]
v_cvt_pk_bf16_f32 v233, v234, v235
v_mul_f32 v240, s32, v240
v_mfma_f32_16x16x32_bf16 v[252:255], v[28:31], v[16:19], v[252:255]
ds_write_b64 v7, v[232:233] offset:10240
v_mul_f32 v241, s32, v241
v_mfma_f32_16x16x32_bf16 v[252:255], v[32:35], v[36:39], v[252:255]
v_mul_f32 v242, s32, v242
v_mul_f32 v243, s32, v243
v_mfma_f32_16x16x32_bf16 v[252:255], v[172:175], v[164:167], v[252:255]
v_mul_f32 v244, s34, v244
v_mul_f32 v245, s34, v245
v_mfma_f32_16x16x32_bf16 v[252:255], v[180:183], v[212:215], v[252:255]
v_exp_f32 v244, v244
v_mfma_f32_16x16x32_bf16 v[252:255], v[112:115], v[160:163], v[252:255]
v_exp_f32 v245, v245
v_mfma_f32_16x16x32_bf16 v[252:255], v[152:155], v[8:11], v[252:255]
s_waitcnt lgkmcnt(0)
s_barrier
v_mfma_f32_16x16x32_bf16 v[252:255], v[84:87], v[192:195], v[252:255]
v_mul_f32 v246, s34, v246
v_mul_f32 v247, s34, v247
v_mfma_f32_16x16x32_bf16 v[252:255], v[96:99], v[200:203], v[252:255]
v_exp_f32 v246, v246
v_mfma_f32_16x16x32_bf16 v[252:255], v[104:107], v[44:47], v[252:255]
v_exp_f32 v247, v247
v_min_f32 v240, s28, v240
v_min_f32 v241, s28, v241
v_min_f32 v242, s28, v242
v_min_f32 v243, s28, v243
v_exp_f32 v240, v240
v_exp_f32 v241, v241
v_exp_f32 v242, v242
v_exp_f32 v243, v243
v_pk_add_f32 v[244:245], s[30:31], v[244:245]
v_pk_add_f32 v[246:247], s[30:31], v[246:247]
v_pk_fma_f32 v[244:245], v[240:241], v[244:245], v[244:245]
v_pk_fma_f32 v[246:247], v[242:243], v[246:247], v[246:247]
v_rcp_f32 v244, v244
v_rcp_f32 v245, v245
v_rcp_f32 v246, v246
v_rcp_f32 v247, v247
v_pk_fma_f32 v[240:241], v[240:241], v[244:245], v[244:245] neg_lo:[0,0,1] neg_hi:[0,0,1]
v_pk_fma_f32 v[242:243], v[242:243], v[246:247], v[246:247] neg_lo:[0,0,1] neg_hi:[0,0,1]
v_cvt_pk_bf16_f32 v240, v240, v241
v_cvt_pk_bf16_f32 v241, v242, v243
v_pk_mul_f32 v[248:249], s[32:33], v[248:249]
ds_write_b64 v7, v[240:241] offset:12288
v_pk_mul_f32 v[250:251], s[32:33], v[250:251]
v_pk_mul_f32 v[252:253], s[34:35], v[252:253]
v_pk_mul_f32 v[254:255], s[34:35], v[254:255]
v_min_f32 v248, s28, v248
v_min_f32 v249, s28, v249
v_min_f32 v250, s28, v250
v_min_f32 v251, s28, v251
v_exp_f32 v252, v252
v_exp_f32 v253, v253
v_exp_f32 v254, v254
v_exp_f32 v255, v255
v_exp_f32 v248, v248
v_exp_f32 v249, v249
v_exp_f32 v250, v250
v_exp_f32 v251, v251
v_pk_add_f32 v[252:253], s[30:31], v[252:253]
v_pk_add_f32 v[254:255], s[30:31], v[254:255]
v_pk_fma_f32 v[252:253], v[248:249], v[252:253], v[252:253]
v_pk_fma_f32 v[254:255], v[250:251], v[254:255], v[254:255]
v_rcp_f32 v252, v252
v_rcp_f32 v253, v253
v_rcp_f32 v254, v254
v_rcp_f32 v255, v255
v_pk_fma_f32 v[248:249], v[248:249], v[252:253], v[252:253] neg_lo:[0,0,1] neg_hi:[0,0,1]
v_pk_fma_f32 v[250:251], v[250:251], v[254:255], v[254:255] neg_lo:[0,0,1] neg_hi:[0,0,1]
v_cvt_pk_bf16_f32 v248, v248, v249
v_cvt_pk_bf16_f32 v249, v250, v251
ds_write_b64 v7, v[248:249] offset:14336
s_waitcnt lgkmcnt(0)
s_barrier
L_end:
s_endpgm
.p2align 11
L_loader2:
s_load_dwordx2 s[96:97], s[0:1], 16
s_bfe_u32 s12, s12, 0x20006
s_waitcnt vmcnt(6)
s_barrier
s_add_u32 m0, s23, 54784
s_nop 0
buffer_load_dwordx4 v7, s[8:11], s27 offen offset:512 lds
s_waitcnt vmcnt(5)
s_barrier
s_add_u32 m0, s23, 59392
s_add_u32 s27, s82, 786432
buffer_load_dwordx4 v7, s[8:11], s27 offen lds
s_add_u32 m0, s23, 62976
s_nop 0
buffer_load_dwordx4 v7, s[8:11], s27 offen offset:512 lds
s_add_u32 m0, s23, 67584
s_add_u32 s27, s82, 1048576
buffer_load_dwordx4 v7, s[8:11], s27 offen lds
s_add_u32 m0, s23, 71168
s_nop 0
buffer_load_dwordx4 v7, s[8:11], s27 offen offset:512 lds
s_add_u32 s84, s94, 1
s_and_b32 s84, s84, 3
s_lshl_b32 s84, s84, 16
s_lshr_b32 s72, s2, 5
s_lshl_b32 s72, s72, 18
s_and_b32 s73, s2, 0x18
s_lshl_b32 s73, s73, 11
s_add_u32 s72, s72, s73
s_lshl_b32 s73, s12, 12
s_add_u32 s72, s72, s73
s_add_u32 s73, s72, s84
s_buffer_load_dword s76, s[8:11], s73 offset:384
s_buffer_load_dword s76, s[8:11], s73 offset:448
s_buffer_load_dword s76, s[8:11], s73 offset:1408
s_buffer_load_dword s76, s[8:11], s73 offset:1472
s_buffer_load_dword s76, s[8:11], s73 offset:2432
s_buffer_load_dword s76, s[8:11], s73 offset:2496
s_buffer_load_dword s76, s[8:11], s73 offset:3456
s_buffer_load_dword s76, s[8:11], s73 offset:3520
s_add_u32 s73, s72, s84
s_buffer_load_dword s76, s[8:11], s73 offset:896
s_buffer_load_dword s76, s[8:11], s73 offset:960
s_buffer_load_dword s76, s[8:11], s73 offset:1920
s_buffer_load_dword s76, s[8:11], s73 offset:1984
s_buffer_load_dword s76, s[8:11], s73 offset:2944
s_buffer_load_dword s76, s[8:11], s73 offset:3008
s_waitcnt vmcnt(6)
s_barrier
s_add_u32 s83, s82, 32768
s_add_u32 m0, s23, 75776
s_nop 0
buffer_load_dwordx4 v7, s[8:11], s83 offen lds
s_add_u32 m0, s23, 79360
s_nop 0
buffer_load_dwordx4 v7, s[8:11], s83 offen offset:512 lds
s_add_u32 m0, s23, 83968
s_add_u32 s27, s83, 262144
buffer_load_dwordx4 v7, s[8:11], s27 offen lds
s_waitcnt vmcnt(7)
s_barrier
s_add_u32 m0, s23, 87552
s_nop 0
buffer_load_dwordx4 v7, s[8:11], s27 offen offset:512 lds
s_add_u32 m0, s23, 92160
s_add_u32 s27, s83, 524288
buffer_load_dwordx4 v7, s[8:11], s27 offen lds
s_add_u32 m0, s23, 95744
s_nop 0
buffer_load_dwordx4 v7, s[8:11], s27 offen offset:512 lds
s_add_u32 m0, s23, 100352
s_add_u32 s27, s83, 786432
buffer_load_dwordx4 v7, s[8:11], s27 offen lds
s_waitcnt vmcnt(7)
s_barrier
s_add_u32 m0, s23, 103936
s_nop 0
buffer_load_dwordx4 v7, s[8:11], s27 offen offset:512 lds
s_add_u32 m0, s23, 108544
s_add_u32 s27, s83, 1048576
buffer_load_dwordx4 v7, s[8:11], s27 offen lds
s_add_u32 m0, s23, 112128
s_nop 0
buffer_load_dwordx4 v7, s[8:11], s27 offen offset:512 lds
s_add_u32 s91, s94, 1
s_and_b32 s91, s91, 3
s_lshl_b32 s91, s91, 7
s_add_u32 m0, s22, 17408
s_nop 0
buffer_load_dwordx4 v6, s[4:7], s91 offen lds
s_add_u32 m0, s22, 19712
s_nop 0
buffer_load_dwordx4 v6, s[4:7], s91 offen offset:2048 lds
s_add_u32 m0, s22, 26112
s_nop 0
buffer_load_dwordx4 v4, s[4:7], s91 offen lds
s_add_u32 s73, s72, s84
s_buffer_load_dword s76, s[8:11], s73 offset:3968
s_buffer_load_dword s76, s[8:11], s73 offset:4032
s_add_u32 s92, s94, 2
s_and_b32 s92, s92, 3
s_lshl_b32 s92, s92, 7
s_lshl_b32 s77, s14, 8
s_lshl_b32 s80, s12, 13
s_add_u32 s77, s77, s80
s_add_u32 s77, s77, s24
s_add_u32 s78, s77, s92
s_buffer_load_dword s76, s[4:7], s78 offset:0
s_buffer_load_dword s76, s[4:7], s78 offset:64
s_buffer_load_dword s76, s[4:7], s78 offset:1024
s_buffer_load_dword s76, s[4:7], s78 offset:1088
s_buffer_load_dword s76, s[4:7], s78 offset:2048
s_buffer_load_dword s76, s[4:7], s78 offset:2112
s_buffer_load_dword s76, s[4:7], s78 offset:3072
s_buffer_load_dword s76, s[4:7], s78 offset:3136
s_waitcnt vmcnt(7)
s_barrier
s_add_u32 m0, s22, 28416
s_nop 0
buffer_load_dwordx4 v4, s[4:7], s91 offen offset:2048 lds
s_add_u32 m0, s19, 19456
s_mov_b64 exec, 0xff
buffer_load_dwordx4 v9, s[4:7], s91 offen lds
s_mov_b64 exec, -1
s_add_u32 m0, s23, 116736
s_nop 0
buffer_load_dwordx4 v7, s[8:11], s84 offen lds
s_add_u32 m0, s23, 120320
s_nop 0
buffer_load_dwordx4 v7, s[8:11], s84 offen offset:512 lds
s_add_u32 m0, s23, 124928
s_add_u32 s27, s84, 262144
buffer_load_dwordx4 v7, s[8:11], s27 offen lds
s_add_u32 m0, s23, 128512
s_nop 0
buffer_load_dwordx4 v7, s[8:11], s27 offen offset:512 lds
s_add_u32 s78, s77, s92
s_buffer_load_dword s76, s[4:7], s78 offset:4096
s_buffer_load_dword s76, s[4:7], s78 offset:4160
s_buffer_load_dword s76, s[4:7], s78 offset:5120
s_buffer_load_dword s76, s[4:7], s78 offset:5184
s_buffer_load_dword s76, s[4:7], s78 offset:6144
s_buffer_load_dword s76, s[4:7], s78 offset:6208
s_buffer_load_dword s76, s[4:7], s78 offset:7168
s_buffer_load_dword s76, s[4:7], s78 offset:7232
s_waitcnt vmcnt(9)
s_barrier
s_add_u32 m0, s23, 133120
s_add_u32 s27, s84, 524288
buffer_load_dwordx4 v7, s[8:11], s27 offen lds
s_add_u32 m0, s23, 136704
s_nop 0
buffer_load_dwordx4 v7, s[8:11], s27 offen offset:512 lds
s_add_u32 m0, s23, 141312
s_add_u32 s27, s84, 786432
buffer_load_dwordx4 v7, s[8:11], s27 offen lds
s_add_u32 m0, s23, 144896
s_nop 0
buffer_load_dwordx4 v7, s[8:11], s27 offen offset:512 lds
s_add_u32 m0, s23, 149504
s_add_u32 s27, s84, 1048576
buffer_load_dwordx4 v7, s[8:11], s27 offen lds
s_add_u32 m0, s23, 153088
s_nop 0
buffer_load_dwordx4 v7, s[8:11], s27 offen offset:512 lds
s_add_u32 s85, s84, 32768
s_add_u32 m0, s23, 34816
s_nop 0
buffer_load_dwordx4 v7, s[8:11], s85 offen lds
s_add_u32 s86, s94, 2
s_and_b32 s86, s86, 3
s_lshl_b32 s86, s86, 16
s_add_u32 s73, s72, s86
s_buffer_load_dword s76, s[8:11], s73 offset:384
s_buffer_load_dword s76, s[8:11], s73 offset:448
s_buffer_load_dword s76, s[8:11], s73 offset:1408
s_buffer_load_dword s76, s[8:11], s73 offset:1472
s_buffer_load_dword s76, s[8:11], s73 offset:2432
s_buffer_load_dword s76, s[8:11], s73 offset:2496
s_buffer_load_dword s76, s[8:11], s73 offset:3456
s_buffer_load_dword s76, s[8:11], s73 offset:3520
s_waitcnt vmcnt(7)
s_barrier
s_add_u32 m0, s23, 38400
s_nop 0
buffer_load_dwordx4 v7, s[8:11], s85 offen offset:512 lds
s_add_u32 m0, s23, 43008
s_add_u32 s27, s85, 262144
buffer_load_dwordx4 v7, s[8:11], s27 offen lds
s_add_u32 m0, s23, 46592
s_nop 0
buffer_load_dwordx4 v7, s[8:11], s27 offen offset:512 lds
s_add_u32 m0, s23, 51200
s_add_u32 s27, s85, 524288
buffer_load_dwordx4 v7, s[8:11], s27 offen lds
s_add_u32 m0, s23, 54784
s_nop 0
buffer_load_dwordx4 v7, s[8:11], s27 offen offset:512 lds
s_add_u32 m0, s23, 59392
s_add_u32 s27, s85, 786432
buffer_load_dwordx4 v7, s[8:11], s27 offen lds
s_add_u32 m0, s23, 62976
s_nop 0
buffer_load_dwordx4 v7, s[8:11], s27 offen offset:512 lds
s_add_u32 s73, s72, s86
s_buffer_load_dword s76, s[8:11], s73 offset:896
s_buffer_load_dword s76, s[8:11], s73 offset:960
s_buffer_load_dword s76, s[8:11], s73 offset:1920
s_buffer_load_dword s76, s[8:11], s73 offset:1984
s_buffer_load_dword s76, s[8:11], s73 offset:2944
s_buffer_load_dword s76, s[8:11], s73 offset:3008
s_buffer_load_dword s76, s[8:11], s73 offset:3968
s_buffer_load_dword s76, s[8:11], s73 offset:4032
s_waitcnt vmcnt(8)
s_barrier
s_add_u32 m0, s23, 67584
s_add_u32 s27, s85, 1048576
buffer_load_dwordx4 v7, s[8:11], s27 offen lds
s_add_u32 m0, s23, 71168
s_nop 0
buffer_load_dwordx4 v7, s[8:11], s27 offen offset:512 lds
s_add_u32 m0, s22, 0
s_nop 0
buffer_load_dwordx4 v6, s[4:7], s92 offen lds
s_add_u32 m0, s22, 2304
s_nop 0
buffer_load_dwordx4 v6, s[4:7], s92 offen offset:2048 lds
s_add_u32 m0, s22, 8704
s_nop 0
buffer_load_dwordx4 v4, s[4:7], s92 offen lds
s_add_u32 m0, s22, 11008
s_nop 0
buffer_load_dwordx4 v4, s[4:7], s92 offen offset:2048 lds
s_add_u32 m0, s19, 2048
s_mov_b64 exec, 0xff
buffer_load_dwordx4 v9, s[4:7], s92 offen lds
s_mov_b64 exec, -1
s_add_u32 m0, s23, 75776
s_nop 0
buffer_load_dwordx4 v7, s[8:11], s86 offen lds
s_add_u32 m0, s23, 79360
s_nop 0
buffer_load_dwordx4 v7, s[8:11], s86 offen offset:512 lds
s_add_u32 m0, s23, 83968
s_add_u32 s27, s86, 262144
buffer_load_dwordx4 v7, s[8:11], s27 offen lds
s_add_u32 s93, s94, 3
s_and_b32 s93, s93, 3
s_lshl_b32 s93, s93, 7
s_add_u32 s78, s77, s93
s_buffer_load_dword s76, s[4:7], s78 offset:0
s_buffer_load_dword s76, s[4:7], s78 offset:64
s_buffer_load_dword s76, s[4:7], s78 offset:1024
s_buffer_load_dword s76, s[4:7], s78 offset:1088
s_buffer_load_dword s76, s[4:7], s78 offset:2048
s_buffer_load_dword s76, s[4:7], s78 offset:2112
s_buffer_load_dword s76, s[4:7], s78 offset:3072
s_buffer_load_dword s76, s[4:7], s78 offset:3136
s_waitcnt vmcnt(8)
s_barrier
s_add_u32 m0, s23, 87552
s_nop 0
buffer_load_dwordx4 v7, s[8:11], s27 offen offset:512 lds
s_add_u32 m0, s23, 92160
s_add_u32 s27, s86, 524288
buffer_load_dwordx4 v7, s[8:11], s27 offen lds
s_add_u32 m0, s23, 95744
s_nop 0
buffer_load_dwordx4 v7, s[8:11], s27 offen offset:512 lds
s_add_u32 m0, s23, 100352
s_add_u32 s27, s86, 786432
buffer_load_dwordx4 v7, s[8:11], s27 offen lds
s_add_u32 m0, s23, 103936
s_nop 0
buffer_load_dwordx4 v7, s[8:11], s27 offen offset:512 lds
s_add_u32 m0, s23, 108544
s_add_u32 s27, s86, 1048576
buffer_load_dwordx4 v7, s[8:11], s27 offen lds
s_add_u32 m0, s23, 112128
s_nop 0
buffer_load_dwordx4 v7, s[8:11], s27 offen offset:512 lds
s_add_u32 s87, s86, 32768
s_add_u32 m0, s23, 116736
s_nop 0
buffer_load_dwordx4 v7, s[8:11], s87 offen lds
s_add_u32 m0, s23, 120320
s_nop 0
buffer_load_dwordx4 v7, s[8:11], s87 offen offset:512 lds
s_add_u32 m0, s23, 124928
s_add_u32 s27, s87, 262144
buffer_load_dwordx4 v7, s[8:11], s27 offen lds
s_add_u32 m0, s23, 128512
s_nop 0
buffer_load_dwordx4 v7, s[8:11], s27 offen offset:512 lds
s_add_u32 m0, s23, 133120
s_add_u32 s27, s87, 524288
buffer_load_dwordx4 v7, s[8:11], s27 offen lds
s_add_u32 m0, s23, 136704
s_nop 0
buffer_load_dwordx4 v7, s[8:11], s27 offen offset:512 lds
s_add_u32 m0, s23, 141312
s_add_u32 s27, s87, 786432
buffer_load_dwordx4 v7, s[8:11], s27 offen lds
s_add_u32 s78, s77, s93
s_buffer_load_dword s76, s[4:7], s78 offset:4096
s_buffer_load_dword s76, s[4:7], s78 offset:4160
s_buffer_load_dword s76, s[4:7], s78 offset:5120
s_buffer_load_dword s76, s[4:7], s78 offset:5184
s_buffer_load_dword s76, s[4:7], s78 offset:6144
s_buffer_load_dword s76, s[4:7], s78 offset:6208
s_buffer_load_dword s76, s[4:7], s78 offset:7168
s_buffer_load_dword s76, s[4:7], s78 offset:7232
s_waitcnt vmcnt(7)
s_barrier
s_add_u32 m0, s23, 144896
s_nop 0
buffer_load_dwordx4 v7, s[8:11], s27 offen offset:512 lds
s_add_u32 m0, s23, 149504
s_add_u32 s27, s87, 1048576
buffer_load_dwordx4 v7, s[8:11], s27 offen lds
s_add_u32 m0, s23, 153088
s_nop 0
buffer_load_dwordx4 v7, s[8:11], s27 offen offset:512 lds
s_add_u32 s88, s94, 3
s_and_b32 s88, s88, 3
s_lshl_b32 s88, s88, 16
s_add_u32 m0, s23, 34816
s_nop 0
buffer_load_dwordx4 v7, s[8:11], s88 offen lds
s_add_u32 m0, s23, 38400
s_nop 0
buffer_load_dwordx4 v7, s[8:11], s88 offen offset:512 lds
s_add_u32 m0, s23, 43008
s_add_u32 s27, s88, 262144
buffer_load_dwordx4 v7, s[8:11], s27 offen lds
s_add_u32 m0, s23, 46592
s_nop 0
buffer_load_dwordx4 v7, s[8:11], s27 offen offset:512 lds
s_add_u32 m0, s23, 51200
s_add_u32 s27, s88, 524288
buffer_load_dwordx4 v7, s[8:11], s27 offen lds
s_add_u32 m0, s23, 54784
s_nop 0
buffer_load_dwordx4 v7, s[8:11], s27 offen offset:512 lds
s_add_u32 m0, s23, 59392
s_add_u32 s27, s88, 786432
buffer_load_dwordx4 v7, s[8:11], s27 offen lds
s_waitcnt vmcnt(7)
s_barrier
s_add_u32 m0, s23, 62976
s_nop 0
buffer_load_dwordx4 v7, s[8:11], s27 offen offset:512 lds
s_add_u32 m0, s23, 67584
s_add_u32 s27, s88, 1048576
buffer_load_dwordx4 v7, s[8:11], s27 offen lds
s_add_u32 m0, s23, 71168
s_nop 0
buffer_load_dwordx4 v7, s[8:11], s27 offen offset:512 lds
s_add_u32 m0, s22, 17408
s_nop 0
buffer_load_dwordx4 v6, s[4:7], s93 offen lds
s_add_u32 m0, s22, 19712
s_nop 0
buffer_load_dwordx4 v6, s[4:7], s93 offen offset:2048 lds
s_add_u32 m0, s22, 26112
s_nop 0
buffer_load_dwordx4 v4, s[4:7], s93 offen lds
s_add_u32 m0, s22, 28416
s_nop 0
buffer_load_dwordx4 v4, s[4:7], s93 offen offset:2048 lds
s_add_u32 m0, s19, 19456
s_mov_b64 exec, 0xff
buffer_load_dwordx4 v9, s[4:7], s93 offen lds
s_mov_b64 exec, -1
s_add_u32 s89, s88, 32768
s_add_u32 m0, s23, 75776
s_nop 0
buffer_load_dwordx4 v7, s[8:11], s89 offen lds
s_add_u32 m0, s23, 79360
s_nop 0
buffer_load_dwordx4 v7, s[8:11], s89 offen offset:512 lds
s_add_u32 m0, s23, 83968
s_add_u32 s27, s89, 262144
buffer_load_dwordx4 v7, s[8:11], s27 offen lds
s_add_u32 m0, s23, 87552
s_nop 0
buffer_load_dwordx4 v7, s[8:11], s27 offen offset:512 lds
s_add_u32 m0, s23, 92160
s_add_u32 s27, s89, 524288
buffer_load_dwordx4 v7, s[8:11], s27 offen lds
s_add_u32 m0, s23, 95744
s_nop 0
buffer_load_dwordx4 v7, s[8:11], s27 offen offset:512 lds
s_add_u32 m0, s23, 100352
s_add_u32 s27, s89, 786432
buffer_load_dwordx4 v7, s[8:11], s27 offen lds
s_add_u32 m0, s23, 103936
s_nop 0
buffer_load_dwordx4 v7, s[8:11], s27 offen offset:512 lds
s_add_u32 m0, s23, 108544
s_add_u32 s27, s89, 1048576
buffer_load_dwordx4 v7, s[8:11], s27 offen lds
s_add_u32 m0, s23, 112128
s_nop 0
buffer_load_dwordx4 v7, s[8:11], s27 offen offset:512 lds
v_bfe_u32 v1, v0, 3, 3
s_lshr_b32 s20, s12, 1
s_and_b32 s21, s12, 1
v_xor_b32 v10, v1, v2
v_lshl_add_u32 v10, v1, 3, v10
v_lshlrev_b32 v11, 13, v1
v_lshl_add_u32 v11, v2, 4, v11
s_lshl_b32 s25, s20, 16
s_lshl_b32 s24, s20, 10
s_lshl_b32 s26, s21, 11
s_add_u32 s24, s24, s26
s_add_u32 s24, s24, 116736
v_lshl_add_u32 v13, v10, 4, s24
s_lshl_b32 s26, s21, 10
s_add_u32 s25, s25, s26
s_add_u32 s25, s25, s14
s_add_u32 s25, s25, s18
v_add_u32 v14, s25, v11
s_waitcnt lgkmcnt(0)
s_add_u32 s96, s96, s17
s_addc_u32 s97, s97, 0
s_mov_b32 s98, 2048000
s_mov_b32 s99, 0x20000
s_mov_b32 s74, 4096
s_waitcnt vmcnt(10)
s_barrier
s_waitcnt vmcnt(0)
s_barrier
s_barrier
ds_read_b128 v[16:19], v13 offset:0
s_waitcnt lgkmcnt(0)
buffer_store_dwordx4 v[16:19], v14, s[96:99], 0 offen offset:0 sc0 sc1
s_barrier
ds_read_b128 v[20:23], v13 offset:4096
s_waitcnt lgkmcnt(0)
buffer_store_dwordx4 v[20:23], v14, s[96:99], 0 offen offset:2048 sc0 sc1
s_barrier
ds_read_b128 v[24:27], v13 offset:8192
s_waitcnt lgkmcnt(0)
buffer_store_dwordx4 v[24:27], v14, s[96:99], s74 offen offset:0 sc0 sc1
s_barrier
ds_read_b128 v[28:31], v13 offset:12288
s_waitcnt lgkmcnt(0)
buffer_store_dwordx4 v[28:31], v14, s[96:99], s74 offen offset:2048 sc0 sc1
s_endpgm
.section .rodata,"a"
.p2align 6
.amdhsa_kernel standalone__autoregressive_conv_wavernn__speech_kernel
  .amdhsa_next_free_vgpr 256
  .amdhsa_next_free_sgpr 102
  .amdhsa_accum_offset 256
  .amdhsa_group_segment_fixed_size 0
  .amdhsa_kernarg_size 40
  .amdhsa_user_sgpr_count 2
  .amdhsa_user_sgpr_kernarg_segment_ptr 1
  .amdhsa_system_sgpr_workgroup_id_x 1
.end_amdhsa_kernel
```
